```python
import torch

def _softmax(x, axis=-1):
    return torch.softmax(x, dim=axis)
def _gelu(x):
    return torch.nn.functional.gelu(x, approximate="tanh")
def _silu(x):
    return torch.nn.functional.silu(x)
def _sigmoid(x):
    return torch.sigmoid(x)
def _layernorm(x, axis=-1, eps=1e-5):
    m = x.mean(dim=axis, keepdim=True)
    v = x.var(dim=axis, keepdim=True, unbiased=False)
    return (x - m) / torch.sqrt(v + eps)
def _scatter_add(tgt, idx, src, axis=0):
    return tgt.clone().index_add_(axis, idx, src)
def _segment_sum(src, seg, n):
    out = torch.zeros((n,) + src.shape[1:], dtype=src.dtype)
    return out.index_add_(0, seg, src)
def _pad(x, pw):
    flat = tuple(v for pair in reversed(pw) for v in pair)
    return torch.nn.functional.pad(x, flat)

kernel_name = 'concat_heads__softmax_full_mha__linear_kernel_hedgehog__prompt'

def setup_inputs():

    _w = (lambda a: (lambda t: t.to(torch.bfloat16) if t.is_floating_point() else t)(torch.as_tensor(a)))
    def _A_setup():
        B, S, D = 1, 2048, 1024
        return {
            "x": _w((lambda *s: torch.randn(*s, dtype=torch.bfloat16) * 0.2)(B, S, D)),
            "wqkv": _w((lambda *s: torch.randn(*s, dtype=torch.bfloat16) * 0.2)(D, 3 * D)),
            "wo": _w((lambda *s: torch.randn(*s, dtype=torch.bfloat16) * 0.05)(D, D)),
        }
    _A_in = _A_setup()

    def _B_setup():
        B, S, D, H = 1, 2048, 1024, 32
        Dh = D // H
        return {
            "x": _w((lambda *s: torch.randn(*s, dtype=torch.bfloat16) * 0.4)(B, S, D)),
            "wqkv": _w((lambda *s: torch.randn(*s, dtype=torch.bfloat16) * 0.4)(D, 3 * D)),
            "w_phi": _w((lambda *s: torch.randn(*s, dtype=torch.bfloat16) * 0.4)(H, Dh, Dh) * (Dh ** -0.5)),
            "wo": _w((lambda *s: torch.randn(*s, dtype=torch.bfloat16) * 0.05)(D, D)),
        }
    _B_in = _B_setup()

    return {
        "A_x": _A_in["x"],
        "A_wqkv": _A_in["wqkv"],
        "A_wo": _A_in["wo"],
        "B_x": _B_in["x"],
        "B_wqkv": _B_in["wqkv"],
        "B_w_phi": _B_in["w_phi"],
        "B_wo": _B_in["wo"],
    }

def reference(A_x, A_wqkv, A_wo, B_x, B_wqkv, B_w_phi, B_wo):
    def _A_ref(x, wqkv, wo):
        B, S, D = x.shape
        H = 32; Dh = D // H
        qkv = (lambda x, *d: x.permute(*d))((x @ wqkv).reshape(B, S, 3, H, Dh), 2, 0, 3, 1, 4)
        q, k, v = qkv[0], qkv[1], qkv[2]
        scale = Dh ** -0.5
        scores = torch.einsum("bhqd,bhkd->bhqk", q, k) * scale
        p = _softmax(scores, axis=-1)
        o = torch.einsum("bhqk,bhkd->bhqd", p, v)
        return (lambda x, *d: x.permute(*d))(o, 0, 2, 1, 3).reshape(B, S, D) @ wo

    def _B_ref(x, wqkv, w_phi, wo):
        B, S, D = x.shape
        H = 32; Dh = D // H
        qkv = (lambda x, *d: x.permute(*d))((x @ wqkv).reshape(B, S, 3, H, Dh), 2, 0, 3, 1, 4)
        q, k, v = qkv[0], qkv[1], qkv[2]
        pq = torch.einsum("bhsd,hdf->bhsf", q, w_phi)
        pk = torch.einsum("bhsd,hdf->bhsf", k, w_phi)
        phi_q = torch.concatenate([_softmax(pq, axis=-1), _softmax(-pq, axis=-1)], axis=-1)
        phi_k = torch.concatenate([_softmax(pk, axis=-1), _softmax(-pk, axis=-1)], axis=-1)
        kv = torch.einsum("bhsf,bhsd->bhfd", phi_k, v)
        z  = torch.einsum("bhsf->bhf", phi_k)
        num = torch.einsum("bhqf,bhfd->bhqd", phi_q, kv)
        den = torch.einsum("bhqf,bhf->bhq", phi_q, z)[..., None] + 1e-6
        o = num / den
        return (lambda x, *d: x.permute(*d))(o, 0, 2, 1, 3).reshape(B, S, D) @ wo

    a = _A_ref(A_x, A_wqkv, A_wo)
    b = _B_ref(B_x, B_wqkv, B_w_phi, B_wo)
    return torch.concatenate([a, b], axis=-1)
```

```asm
; @launch grid=(256,1,1) block=(768,1,1) lds=163840
.amdgcn_target "amdgcn-amd-amdhsa--gfx950"
.text
.p2align 8
.globl concat_heads__softmax_full_mha__linear_kernel_hedgehog__prompt_kernel
.type concat_heads__softmax_full_mha__linear_kernel_hedgehog__prompt_kernel,@function
concat_heads__softmax_full_mha__linear_kernel_hedgehog__prompt_kernel:
  s_cmp_ge_u32 s2, 256
  s_cbranch_scc1 END

  s_load_dwordx16 s[4:19], s[0:1], 0
  s_load_dwordx4 s[20:23], s[0:1], 64
  v_and_b32 v1, 63, v0
  v_lshrrev_b32 v3, 6, v0
  s_mov_b32 s28, 1069066811
  v_readfirstlane_b32 s24, v3
  v_lshlrev_b32 v2, 4, v1
  s_and_b32 s29, s24, 3

CODE_BEG:
  s_cmp_lt_u32 s24, 8
  s_cbranch_scc1 COMP
  s_and_b32 s64, s2, 7
  s_lshr_b32 s65, s2, 3
  s_lshr_b32 s48, s65, 4
  s_and_b32 s49, s64, 4
  s_and_b32 s66, s65, 3
  s_add_u32 s49, s49, s66
  s_and_b32 s50, s64, 3
  s_lshl_b32 s50, s50, 2
  s_bfe_u32 s66, s65, 0x20002
  s_add_u32 s50, s50, s66

  s_setprio 3
  v_lshrrev_b32 v10, 3, v1
  v_and_b32 v11, 7, v1
  v_lshrrev_b32 v12, 4, v1
  v_xor_b32 v11, v11, v12
  v_lshlrev_b32 v11, 4, v11
  v_lshl_add_u32 v3, v10, 11, v11
  v_xor_b32 v4, 64, v3
  v_add_u32 v4, 15360, v4
  v_add_u32 v5, 30720, v3
  v_add_u32 v6, 30720, v4
  s_mul_i32 s64, s29, 24
  s_mov_b32 s65, 6144

  v_lshrrev_b32 v10, 3, v1
  v_add3_u32 v10, v10, s64, 0
  v_lshrrev_b32 v11, 5, v10
  v_and_b32 v10, 31, v10
  v_mul_lo_u32 v12, v10, s65
  v_lshl_add_u32 v12, v11, 11, v12
  v_and_b32 v11, 2, v10
  v_lshrrev_b32 v10, 1, v10
  v_and_b32 v10, 4, v10
  v_or_b32 v10, v10, v11
  v_and_b32 v11, 7, v1
  v_xor_b32 v11, v11, v10
  v_lshl_add_u32 v7, v11, 4, v12

  v_lshrrev_b32 v10, 3, v1
  v_add3_u32 v10, v10, s64, 8
  v_lshrrev_b32 v11, 5, v10
  v_and_b32 v10, 31, v10
  v_mul_lo_u32 v12, v10, s65
  v_lshl_add_u32 v12, v11, 11, v12
  v_and_b32 v11, 2, v10
  v_lshrrev_b32 v10, 1, v10
  v_and_b32 v10, 4, v10
  v_or_b32 v10, v10, v11
  v_and_b32 v11, 7, v1
  v_xor_b32 v11, v11, v10
  v_lshl_add_u32 v8, v11, 4, v12

  v_subrev_u32 v8, 1024, v8
  v_lshrrev_b32 v10, 3, v1
  v_add3_u32 v10, v10, s64, 16
  v_lshrrev_b32 v11, 5, v10
  v_and_b32 v10, 31, v10
  v_mul_lo_u32 v12, v10, s65
  v_lshl_add_u32 v12, v11, 11, v12
  v_and_b32 v11, 2, v10
  v_lshrrev_b32 v10, 1, v10
  v_and_b32 v10, 4, v10
  v_or_b32 v10, v10, v11
  v_and_b32 v11, 7, v1
  v_xor_b32 v11, v11, v10
  v_lshl_add_u32 v9, v11, 4, v12

  v_subrev_u32 v9, 2048, v9
  s_lshl_b32 s54, s49, 8
  s_lshl_b32 s64, s29, 5
  s_add_u32 s54, s54, s64
  s_lshl_b32 s54, s54, 11
  s_lshl_b32 s55, s50, 7
  s_lshl_b32 s56, s29, 12
  s_mul_i32 s57, s29, 3072
  s_add_u32 s57, s57, 98304
  s_waitcnt lgkmcnt(0)
  s_cmp_eq_u32 s48, 0
  s_cselect_b64 s[36:37], s[4:5], s[10:11]
  s_cselect_b64 s[38:39], s[6:7], s[12:13]

  s_mov_b32 s40, s36
  s_and_b32 s41, s37, 0xffff
  s_mov_b32 s42, 4194304
  s_mov_b32 s43, 0x20000
  s_mov_b32 s44, s38
  s_and_b32 s45, s39, 0xffff
  s_mov_b32 s46, 6291456
  s_mov_b32 s47, 0x20000
  s_add_u32 m0, s57, 0
  s_nop 0
  buffer_load_dwordx4 v7, s[44:47], s55 offen offset:0 lds
  buffer_load_dwordx4 v8, s[44:47], s55 offen offset:1024 lds
  buffer_load_dwordx4 v9, s[44:47], s55 offen offset:2048 lds
  s_add_u32 s55, s55, 196608
  s_add_u32 m0, s56, 0
  s_add_u32 s64, s54, 0
  buffer_load_dwordx4 v3, s[40:43], s64 offen offset:0 lds
  buffer_load_dwordx4 v4, s[40:43], s64 offen offset:1024 lds
  buffer_load_dwordx4 v5, s[40:43], s64 offen offset:2048 lds
  buffer_load_dwordx4 v6, s[40:43], s64 offen offset:3072 lds
  s_add_u32 m0, s56, 16384
  s_add_u32 s64, s54, 262144
  buffer_load_dwordx4 v3, s[40:43], s64 offen offset:0 lds
  buffer_load_dwordx4 v4, s[40:43], s64 offen offset:1024 lds
  buffer_load_dwordx4 v5, s[40:43], s64 offen offset:2048 lds
  buffer_load_dwordx4 v6, s[40:43], s64 offen offset:3072 lds
  s_add_u32 m0, s57, 12288
  s_nop 0
  buffer_load_dwordx4 v7, s[44:47], s55 offen offset:0 lds
  buffer_load_dwordx4 v8, s[44:47], s55 offen offset:1024 lds
  buffer_load_dwordx4 v9, s[44:47], s55 offen offset:2048 lds
  s_add_u32 s55, s55, 196608
  s_add_u32 s54, s54, 128
  s_add_u32 m0, s56, 32768
  s_add_u32 s64, s54, 0
  buffer_load_dwordx4 v3, s[40:43], s64 offen offset:0 lds
  buffer_load_dwordx4 v4, s[40:43], s64 offen offset:1024 lds
  buffer_load_dwordx4 v5, s[40:43], s64 offen offset:2048 lds
  buffer_load_dwordx4 v6, s[40:43], s64 offen offset:3072 lds
  s_add_u32 m0, s56, 49152
  s_add_u32 s64, s54, 262144
  buffer_load_dwordx4 v3, s[40:43], s64 offen offset:0 lds
  buffer_load_dwordx4 v4, s[40:43], s64 offen offset:1024 lds
  buffer_load_dwordx4 v5, s[40:43], s64 offen offset:2048 lds
  buffer_load_dwordx4 v6, s[40:43], s64 offen offset:3072 lds
  s_mov_b32 s32, s22
  s_and_b32 s33, s23, 0xffff
  s_mov_b32 s34, 38797312
  s_mov_b32 s35, 0x20000
  s_add_u32 s54, s54, 128
  s_mov_b32 s58, 0
  s_add_u32 s60, s56, 65536
  s_add_u32 s59, s56, 98304
  s_mov_b32 s61, 24576

  v_mov_b32 v14, 163776
  v_mov_b32 v16, 0
  v_mov_b32 v17, 0
  v_mov_b32 v18, 0
  v_mov_b32 v19, 0
  ds_write_b128 v14, v[16:19]
  ds_write_b128 v14, v[16:19] offset:16
  v_mov_b32 v15, 1
  s_mov_b32 s68, 0
  s_lshl_b32 s64, s29, 10
  s_add_u32 m0, s64, 155648
  s_lshl_b32 s65, s50, 12
  s_add_u32 s65, s65, s64

  s_mov_b32 s72, s14
  s_and_b32 s73, s15, 0xffff
  s_mov_b32 s74, 65536
  s_mov_b32 s75, 0x20000
  s_waitcnt vmcnt(8) lgkmcnt(0)
  s_barrier
  buffer_load_dwordx4 v2, s[72:75], s65 offen lds
P1_LDL:
  s_add_u32 m0, s57, s61
  s_nop 0
  buffer_load_dwordx4 v7, s[44:47], s55 offen offset:0 lds
  buffer_load_dwordx4 v8, s[44:47], s55 offen offset:1024 lds
  buffer_load_dwordx4 v9, s[44:47], s55 offen offset:2048 lds
  s_add_u32 s55, s55, 196608
  s_add_u32 s66, s61, 12288
  s_add_u32 m0, s57, s66
  s_nop 0
  buffer_load_dwordx4 v7, s[44:47], s55 offen offset:0 lds
  buffer_load_dwordx4 v8, s[44:47], s55 offen offset:1024 lds
  buffer_load_dwordx4 v9, s[44:47], s55 offen offset:2048 lds
  s_add_u32 s55, s55, 196608
  s_add_u32 m0, s60, 0
  s_add_u32 s64, s54, 0
  buffer_load_dwordx4 v3, s[40:43], s64 offen offset:0 lds
  buffer_load_dwordx4 v4, s[40:43], s64 offen offset:1024 lds
  buffer_load_dwordx4 v5, s[40:43], s64 offen offset:2048 lds
  buffer_load_dwordx4 v6, s[40:43], s64 offen offset:3072 lds
  s_add_u32 m0, s60, 16384
  s_add_u32 s64, s54, 262144
  buffer_load_dwordx4 v3, s[40:43], s64 offen offset:0 lds
  buffer_load_dwordx4 v4, s[40:43], s64 offen offset:1024 lds
  buffer_load_dwordx4 v5, s[40:43], s64 offen offset:2048 lds
  buffer_load_dwordx4 v6, s[40:43], s64 offen offset:3072 lds
  s_xor_b32 s61, s61, 24576
  s_waitcnt vmcnt(8)
  s_barrier
  s_add_u32 s54, s54, 128
  s_add_u32 s60, s60, 32768
  s_cmp_eq_u32 s60, s59
  s_cselect_b32 s60, s56, s60
  s_add_u32 s58, s58, 1
  s_cmp_lt_u32 s58, 14
  s_cselect_b32 s42, 4194304, 0
  s_cmp_lt_u32 s58, 16
  s_cbranch_scc1 P1_LDL
  s_waitcnt vmcnt(0)

  s_setprio 0
  v_mov_b32 v160, 0
  s_mov_b32 s38, 0
TN1:
  global_load_dwordx2 v[162:163], v160, s[20:21] sc0 sc1
  s_add_u32 s38, s38, 1
  s_waitcnt vmcnt(0)
  v_readfirstlane_b32 s26, v162
  v_readfirstlane_b32 s27, v163
  s_cmp_gt_u32 s38, 200000
  s_cbranch_scc1 TN1_X
  s_cmp_eq_u32 s26, 0
  s_cbranch_scc1 TN1

TN1_X:
  ds_write_b64 v14, v[162:163] offset:32
  s_waitcnt lgkmcnt(0)
  s_lshl_b32 s64, s48, 4
  s_add_u32 s64, s64, s50
  s_lshl_b32 s64, s64, 3
  s_add_u32 s64, s64, s49
  s_lshl_b32 s64, s64, 7
  s_add_u32 s64, s64, 37748736
  s_add_u32 s65, s64, 16384
  v_mov_b32 v8, s65
  s_add_u32 s69, s64, 32768
  s_barrier

  s_barrier
  s_and_b32 s56, s2, 7
  s_lshr_b32 s57, s2, 3
  s_and_b32 s49, s56, 4
  s_and_b32 s58, s57, 3
  s_add_u32 s49, s49, s58
  s_and_b32 s48, s56, 3
  s_lshl_b32 s48, s48, 2
  s_bfe_u32 s58, s57, 0x20002
  s_add_u32 s48, s48, s58
  s_lshl_b32 s48, s48, 1
  s_lshr_b32 s58, s57, 4
  s_add_u32 s48, s48, s58
  s_lshl_b32 s54, s48, 18
  s_add_u32 s54, s54, 4194304

  v_mov_b32 v14, 163784
  v_mov_b32 v15, 0

  v_mov_b32 v15, 1
  s_lshr_b32 s56, s48, 1
  s_lshl_b32 s56, s56, 10
  s_add_u32 s56, s56, 37748736
  v_lshlrev_b32 v8, 7, v1
  v_add_u32 v8, s56, v8
  v_add_u32 v5, s49, v1
  v_and_b32 v5, 7, v5
  v_lshlrev_b32 v5, 7, v5
  v_add_u32 v5, s56, v5

  v_add_u32 v8, 49152, v8
  s_lshr_b32 s56, s29, 1
  s_lshl_b32 s56, s56, 11
  s_and_b32 s57, s29, 1
  s_lshl_b32 s57, s57, 3
  s_add_u32 s56, s56, s57
  s_add_u32 s56, s56, 131072
  v_add_u32 v6, s56, v2
  v_and_b32 v10, 0x37, v1
  v_lshlrev_b32 v10, 4, v10
  v_bfe_u32 v11, v1, 3, 1
  v_lshl_add_u32 v10, v11, 10, v10
  v_add_u32 v7, 131072, v10
  v_add_u32 v9, 131072, v2

  s_mov_b32 s60, 0
  s_cmp_lt_u32 s2, 128
  s_cbranch_scc1 P2_AUXA
  s_mov_b32 s36, 1
  s_mov_b32 s37, 0
  s_mov_b64 exec, s[36:37]
  s_mov_b32 s38, 0

POLL2:
  buffer_load_dwordx2 v[162:163], v5, s[32:35], 0 offen sc0 sc1
  s_add_u32 s38, s38, 1
  s_waitcnt vmcnt(0)
  v_cmp_ne_u64 vcc, s[26:27], v[162:163]
  s_cmp_gt_u32 s38, 200000
  s_cbranch_scc1 POLL2_X
  s_cbranch_vccz POLL2_X
  s_sleep 4
  s_branch POLL2

POLL2_X:
  s_mov_b64 exec, -1
  s_lshl_b32 s56, s29, 12
  s_lshl_b32 s57, s49, 15
  s_add_u32 s57, s57, s54
  s_add_u32 s57, s57, s56
  s_add_u32 s58, s57, 16384
  s_lshl_b32 s59, s48, 3
  s_add_u32 s59, s59, s49
  s_lshl_b32 s59, s59, 14
  s_add_u32 s59, s59, s56
  s_add_u32 s59, s59, 0

  s_add_u32 m0, s56, 0
  s_nop 0
  buffer_load_dwordx4 v2, s[32:35], s57 offen offset:0 sc1 lds
  buffer_load_dwordx4 v2, s[32:35], s57 offen offset:1024 sc1 lds
  buffer_load_dwordx4 v2, s[32:35], s57 offen offset:2048 sc1 lds
  buffer_load_dwordx4 v2, s[32:35], s57 offen offset:3072 sc1 lds
  s_add_u32 m0, s56, 139264
  s_nop 0
  buffer_load_dwordx4 v2, s[32:35], s59 offen offset:0 sc1 lds
  buffer_load_dwordx4 v2, s[32:35], s59 offen offset:1024 sc1 lds
  buffer_load_dwordx4 v2, s[32:35], s59 offen offset:2048 sc1 lds
  buffer_load_dwordx4 v2, s[32:35], s59 offen offset:3072 sc1 lds
  s_add_u32 m0, s56, 16384
  s_nop 0
  buffer_load_dwordx4 v2, s[32:35], s58 offen offset:0 sc1 lds
  buffer_load_dwordx4 v2, s[32:35], s58 offen offset:1024 sc1 lds
  buffer_load_dwordx4 v2, s[32:35], s58 offen offset:2048 sc1 lds
  buffer_load_dwordx4 v2, s[32:35], s58 offen offset:3072 sc1 lds
  s_waitcnt vmcnt(0)
  v_mov_b32 v13, 163776
  s_mov_b64 exec, 1
  ds_add_u32 v13, v15 offset:4
  s_mov_b64 exec, -1
  s_cmp_lg_u32 s24, 9
  s_cbranch_scc1 NW8_3
  s_mov_b32 s39, 0
  s_cmp_lt_u32 s2, 128
  s_cselect_b32 s37, -2, -1
  s_mov_b64 exec, 0xff
TRK4:
  buffer_load_dwordx2 v[162:163], v5, s[32:35], 0 offen sc0 sc1
  s_add_u32 s39, s39, 1
  s_waitcnt vmcnt(0)
  v_cmp_ne_u64 vcc, s[26:27], v[162:163]
  s_or_b32 s36, vcc_lo, 0x100
  s_and_b32 s36, s36, s37
  s_ff1_i32_b32 s36, s36
  v_mov_b32 v13, s36
  ds_write_b32 v14, v13 offset:4
  s_cmp_gt_u32 s39, 200000
  s_cbranch_scc1 TRK4_X
  s_cmp_ge_u32 s36, 8
  s_cbranch_scc1 TRK4_Y
  s_sleep 8
  s_branch TRK4

TRK4_X:
  v_mov_b32 v13, 8
  ds_write_b32 v14, v13 offset:4
TRK4_Y:
  s_mov_b64 exec, -1
NW8_3:
  s_cmp_lg_u32 s24, 10
  s_cbranch_scc1 NW8_5
  s_mov_b32 s61, 0
SP6:
  ds_read_b32 v13, v14 offset:0
  s_add_u32 s61, s61, 1
  s_waitcnt lgkmcnt(0)
  v_readfirstlane_b32 s52, v13
  s_cmp_gt_u32 s61, 2000000
  s_cbranch_scc1 SP6_X
  s_cmp_ge_u32 s52, 16
  s_cbranch_scc1 SP6_X

  s_sleep 4
  s_branch SP6
SP6_X:
  v_mov_b32 v160, 0
  v_mov_b32 v162, s26
  v_mov_b32 v163, s27
  s_mov_b64 exec, 1

  buffer_store_dwordx2 v[162:163], v160, s[32:35], s69 offen sc0 sc1
  s_mov_b64 exec, -1
NW8_5:
  s_mov_b32 s61, 0
SP7:
  ds_read_b32 v13, v14 offset:0
  s_add_u32 s61, s61, 1
  s_waitcnt lgkmcnt(0)
  v_readfirstlane_b32 s52, v13
  s_cmp_gt_u32 s61, 2000000
  s_cbranch_scc1 SP7_X
  s_cmp_ge_u32 s52, 8
  s_cbranch_scc1 SP7_X

  s_sleep 8
  s_branch SP7
SP7_X:
  s_branch P2_AUXE
P2_AUXA:
  s_cmp_lg_u32 s24, 9
  s_cbranch_scc1 NW8_8
  s_mov_b32 s39, 0
  s_cmp_lt_u32 s2, 128
  s_cselect_b32 s37, -2, -1
  s_mov_b64 exec, 0xff
TRK9:
  buffer_load_dwordx2 v[162:163], v5, s[32:35], 0 offen sc0 sc1
  s_add_u32 s39, s39, 1
  s_waitcnt vmcnt(0)
  v_cmp_ne_u64 vcc, s[26:27], v[162:163]
  s_or_b32 s36, vcc_lo, 0x100
  s_and_b32 s36, s36, s37
  s_ff1_i32_b32 s36, s36
  v_mov_b32 v13, s36
  ds_write_b32 v14, v13 offset:4
  s_cmp_gt_u32 s39, 200000
  s_cbranch_scc1 TRK9_X
  s_cmp_ge_u32 s36, 8
  s_cbranch_scc1 TRK9_Y
  s_sleep 8
  s_branch TRK9

TRK9_X:
  v_mov_b32 v13, 8
  ds_write_b32 v14, v13 offset:4
TRK9_Y:
  s_mov_b64 exec, -1
NW8_8:
  s_add_u32 s58, s69, -16384
  v_mov_b32 v12, s58

  s_mov_b32 s36, 1
  s_mov_b32 s37, 0
  s_mov_b64 exec, s[36:37]
  s_mov_b32 s38, 0

POLL10:
  buffer_load_dwordx2 v[162:163], v12, s[32:35], 0 offen sc0 sc1
  s_add_u32 s38, s38, 1
  s_waitcnt vmcnt(0)
  v_cmp_ne_u64 vcc, s[26:27], v[162:163]
  s_cmp_gt_u32 s38, 200000
  s_cbranch_scc1 POLL10_X
  s_cbranch_vccz POLL10_X
  s_sleep 32
  s_branch POLL10

POLL10_X:
  s_mov_b64 exec, -1
P2_AUXL:
  v_lshrrev_b32 v10, 2, v1
  v_and_b32 v11, 3, v1
  v_lshlrev_b32 v11, 3, v11
  v_lshl_add_u32 v10, v10, 6, v11
  s_and_b32 s56, s48, 1
  s_lshl_b32 s56, s56, 11
  s_add_u32 s56, s56, 155648
  v_add_u32 v10, s56, v10
  s_lshl_b32 s56, s29, 12
  s_lshl_b32 s57, s48, 3
  s_add_u32 s57, s57, s49
  s_lshl_b32 s57, s57, 14
  s_add_u32 s57, s57, s56
  s_add_u32 s57, s57, 12582912

  ds_read_b64_tr_b16 v[32:33], v10 offset:0
  ds_read_b64_tr_b16 v[34:35], v10 offset:1024
  ds_read_b64_tr_b16 v[36:37], v10 offset:32
  ds_read_b64_tr_b16 v[38:39], v10 offset:1056
  buffer_load_dwordx4 v[16:19], v2, s[32:35], s57 offen offset:0 sc1
  buffer_load_dwordx4 v[20:23], v2, s[32:35], s57 offen offset:1024 sc1
  buffer_load_dwordx4 v[24:27], v2, s[32:35], s57 offen offset:2048 sc1
  buffer_load_dwordx4 v[28:31], v2, s[32:35], s57 offen offset:3072 sc1
  s_waitcnt vmcnt(0) lgkmcnt(0)
  v_mfma_f32_16x16x32_bf16 v[40:43], v[32:35], v[16:19], 0
  v_mfma_f32_16x16x32_bf16 v[44:47], v[36:39], v[16:19], 0
  v_mfma_f32_16x16x32_bf16 v[48:51], v[32:35], v[20:23], 0
  v_mfma_f32_16x16x32_bf16 v[52:55], v[36:39], v[20:23], 0
  v_mfma_f32_16x16x32_bf16 v[56:59], v[32:35], v[24:27], 0
  v_mfma_f32_16x16x32_bf16 v[60:63], v[36:39], v[24:27], 0
  v_mfma_f32_16x16x32_bf16 v[64:67], v[32:35], v[28:31], 0
  v_mfma_f32_16x16x32_bf16 v[68:71], v[36:39], v[28:31], 0
  s_nop 7
  v_max3_f32 v152, v40, v41, v42
  v_max3_f32 v156, -v40, -v41, -v42
  v_max3_f32 v153, v48, v49, v50
  v_max3_f32 v157, -v48, -v49, -v50
  v_max3_f32 v154, v56, v57, v58
  v_max3_f32 v158, -v56, -v57, -v58
  v_max3_f32 v155, v64, v65, v66
  v_max3_f32 v159, -v64, -v65, -v66
  v_max3_f32 v152, v152, v43, v44
  v_max3_f32 v156, v156, -v43, -v44
  v_max3_f32 v153, v153, v51, v52
  v_max3_f32 v157, v157, -v51, -v52
  v_max3_f32 v154, v154, v59, v60
  v_max3_f32 v158, v158, -v59, -v60
  v_max3_f32 v155, v155, v67, v68
  v_max3_f32 v159, v159, -v67, -v68
  v_max3_f32 v152, v152, v45, v46
  v_max3_f32 v156, v156, -v45, -v46
  v_max3_f32 v153, v153, v53, v54
  v_max3_f32 v157, v157, -v53, -v54
  v_max3_f32 v154, v154, v61, v62
  v_max3_f32 v158, v158, -v61, -v62
  v_max3_f32 v155, v155, v69, v70
  v_max3_f32 v159, v159, -v69, -v70
  v_max_f32 v152, v152, v47
  v_max_f32 v156, v156, -v47
  v_max_f32 v153, v153, v55
  v_max_f32 v157, v157, -v55
  v_max_f32 v154, v154, v63
  v_max_f32 v158, v158, -v63
  v_max_f32 v155, v155, v71
  v_max_f32 v159, v159, -v71
  s_nop 1
  v_permlane32_swap_b32 v152, v156
  v_permlane32_swap_b32 v153, v157
  v_permlane32_swap_b32 v154, v158
  v_permlane32_swap_b32 v155, v159
  v_max_f32 v152, v152, v156
  v_max_f32 v153, v153, v157
  v_max_f32 v154, v154, v158
  v_max_f32 v155, v155, v159
  s_nop 1
  v_permlane16_swap_b32 v152, v153
  v_permlane16_swap_b32 v154, v155
  s_nop 0
  v_max_f32 v152, v152, v153
  v_max_f32 v154, v154, v155
  v_mul_f32 v152, s28, v152
  v_mul_f32 v154, s28, v154
  s_nop 0
  v_mov_b32 v153, v152
  v_mov_b32 v155, v154
  s_nop 1
  v_permlane16_swap_b32 v152, v153
  v_permlane16_swap_b32 v154, v155
  s_nop 0
  v_mov_b32 v156, v152
  v_mov_b32 v157, v153
  v_mov_b32 v158, v154
  v_mov_b32 v159, v155
  s_nop 1
  v_permlane32_swap_b32 v152, v156
  v_permlane32_swap_b32 v153, v157
  v_permlane32_swap_b32 v154, v158
  v_permlane32_swap_b32 v155, v159
  s_nop 0
  v_fma_f32 v72, -v40, s28, -v156
  v_fma_f32 v40, v40, s28, -v152
  v_fma_f32 v73, -v41, s28, -v156
  v_fma_f32 v41, v41, s28, -v152
  v_fma_f32 v74, -v42, s28, -v156
  v_fma_f32 v42, v42, s28, -v152
  v_fma_f32 v75, -v43, s28, -v156
  v_fma_f32 v43, v43, s28, -v152
  v_fma_f32 v76, -v44, s28, -v156
  v_fma_f32 v44, v44, s28, -v152
  v_fma_f32 v77, -v45, s28, -v156
  v_fma_f32 v45, v45, s28, -v152
  v_fma_f32 v78, -v46, s28, -v156
  v_fma_f32 v46, v46, s28, -v152
  v_fma_f32 v79, -v47, s28, -v156
  v_fma_f32 v47, v47, s28, -v152
  v_fma_f32 v80, -v48, s28, -v157
  v_fma_f32 v48, v48, s28, -v153
  v_fma_f32 v81, -v49, s28, -v157
  v_fma_f32 v49, v49, s28, -v153
  v_fma_f32 v82, -v50, s28, -v157
  v_fma_f32 v50, v50, s28, -v153
  v_fma_f32 v83, -v51, s28, -v157
  v_fma_f32 v51, v51, s28, -v153
  v_fma_f32 v84, -v52, s28, -v157
  v_fma_f32 v52, v52, s28, -v153
  v_fma_f32 v85, -v53, s28, -v157
  v_fma_f32 v53, v53, s28, -v153
  v_fma_f32 v86, -v54, s28, -v157
  v_fma_f32 v54, v54, s28, -v153
  v_fma_f32 v87, -v55, s28, -v157
  v_fma_f32 v55, v55, s28, -v153
  v_fma_f32 v88, -v56, s28, -v158
  v_fma_f32 v56, v56, s28, -v154
  v_fma_f32 v89, -v57, s28, -v158
  v_fma_f32 v57, v57, s28, -v154
  v_fma_f32 v90, -v58, s28, -v158
  v_fma_f32 v58, v58, s28, -v154
  v_fma_f32 v91, -v59, s28, -v158
  v_fma_f32 v59, v59, s28, -v154
  v_fma_f32 v92, -v60, s28, -v158
  v_fma_f32 v60, v60, s28, -v154
  v_fma_f32 v93, -v61, s28, -v158
  v_fma_f32 v61, v61, s28, -v154
  v_fma_f32 v94, -v62, s28, -v158
  v_fma_f32 v62, v62, s28, -v154
  v_fma_f32 v95, -v63, s28, -v158
  v_fma_f32 v63, v63, s28, -v154
  v_fma_f32 v96, -v64, s28, -v159
  v_fma_f32 v64, v64, s28, -v155
  v_fma_f32 v97, -v65, s28, -v159
  v_fma_f32 v65, v65, s28, -v155
  v_fma_f32 v98, -v66, s28, -v159
  v_fma_f32 v66, v66, s28, -v155
  v_fma_f32 v99, -v67, s28, -v159
  v_fma_f32 v67, v67, s28, -v155
  v_fma_f32 v100, -v68, s28, -v159
  v_fma_f32 v68, v68, s28, -v155
  v_fma_f32 v101, -v69, s28, -v159
  v_fma_f32 v69, v69, s28, -v155
  v_fma_f32 v102, -v70, s28, -v159
  v_fma_f32 v70, v70, s28, -v155
  v_fma_f32 v103, -v71, s28, -v159
  v_fma_f32 v71, v71, s28, -v155
  v_exp_f32 v72, v72
  v_exp_f32 v40, v40
  v_exp_f32 v73, v73
  v_exp_f32 v41, v41
  v_exp_f32 v74, v74
  v_exp_f32 v42, v42
  v_exp_f32 v75, v75
  v_exp_f32 v43, v43
  v_exp_f32 v76, v76
  v_exp_f32 v44, v44
  v_exp_f32 v77, v77
  v_exp_f32 v45, v45
  v_exp_f32 v78, v78
  v_exp_f32 v46, v46
  v_exp_f32 v79, v79
  v_exp_f32 v47, v47
  v_exp_f32 v80, v80
  v_exp_f32 v48, v48
  v_exp_f32 v81, v81
  v_exp_f32 v49, v49
  v_exp_f32 v82, v82
  v_exp_f32 v50, v50
  v_exp_f32 v83, v83
  v_exp_f32 v51, v51
  v_exp_f32 v84, v84
  v_exp_f32 v52, v52
  v_exp_f32 v85, v85
  v_exp_f32 v53, v53
  v_exp_f32 v86, v86
  v_exp_f32 v54, v54
  v_exp_f32 v87, v87
  v_exp_f32 v55, v55
  v_exp_f32 v88, v88
  v_exp_f32 v56, v56
  v_exp_f32 v89, v89
  v_exp_f32 v57, v57
  v_exp_f32 v90, v90
  v_exp_f32 v58, v58
  v_exp_f32 v91, v91
  v_exp_f32 v59, v59
  v_exp_f32 v92, v92
  v_exp_f32 v60, v60
  v_exp_f32 v93, v93
  v_exp_f32 v61, v61
  v_exp_f32 v94, v94
  v_exp_f32 v62, v62
  v_exp_f32 v95, v95
  v_exp_f32 v63, v63
  v_exp_f32 v96, v96
  v_exp_f32 v64, v64
  v_exp_f32 v97, v97
  v_exp_f32 v65, v65
  v_exp_f32 v98, v98
  v_exp_f32 v66, v66
  v_exp_f32 v99, v99
  v_exp_f32 v67, v67
  v_exp_f32 v100, v100
  v_exp_f32 v68, v68
  v_exp_f32 v101, v101
  v_exp_f32 v69, v69
  v_exp_f32 v102, v102
  v_exp_f32 v70, v70
  v_exp_f32 v103, v103
  v_exp_f32 v71, v71
  s_nop 0
  v_cvt_pk_bf16_f32 v104, v40, v41
  v_cvt_pk_bf16_f32 v108, v72, v73
  v_cvt_pk_bf16_f32 v105, v42, v43
  v_cvt_pk_bf16_f32 v109, v74, v75
  v_cvt_pk_bf16_f32 v106, v44, v45
  v_cvt_pk_bf16_f32 v110, v76, v77
  v_cvt_pk_bf16_f32 v107, v46, v47
  v_cvt_pk_bf16_f32 v111, v78, v79
  v_cvt_pk_bf16_f32 v112, v48, v49
  v_cvt_pk_bf16_f32 v116, v80, v81
  v_cvt_pk_bf16_f32 v113, v50, v51
  v_cvt_pk_bf16_f32 v117, v82, v83
  v_cvt_pk_bf16_f32 v114, v52, v53
  v_cvt_pk_bf16_f32 v118, v84, v85
  v_cvt_pk_bf16_f32 v115, v54, v55
  v_cvt_pk_bf16_f32 v119, v86, v87
  v_cvt_pk_bf16_f32 v120, v56, v57
  v_cvt_pk_bf16_f32 v124, v88, v89
  v_cvt_pk_bf16_f32 v121, v58, v59
  v_cvt_pk_bf16_f32 v125, v90, v91
  v_cvt_pk_bf16_f32 v122, v60, v61
  v_cvt_pk_bf16_f32 v126, v92, v93
  v_cvt_pk_bf16_f32 v123, v62, v63
  v_cvt_pk_bf16_f32 v127, v94, v95
  v_cvt_pk_bf16_f32 v128, v64, v65
  v_cvt_pk_bf16_f32 v132, v96, v97
  v_cvt_pk_bf16_f32 v129, v66, v67
  v_cvt_pk_bf16_f32 v133, v98, v99
  v_cvt_pk_bf16_f32 v130, v68, v69
  v_cvt_pk_bf16_f32 v134, v100, v101
  v_cvt_pk_bf16_f32 v131, v70, v71
  v_cvt_pk_bf16_f32 v135, v102, v103
  s_cmp_lg_u32 s24, 8
  s_cbranch_scc1 NW8_11
  s_mov_b32 s36, 255
  s_mov_b32 s37, 0
  s_mov_b64 exec, s[36:37]
  s_mov_b32 s38, 0

POLL12:
  buffer_load_dwordx2 v[162:163], v8, s[32:35], 0 offen sc0 sc1
  s_add_u32 s38, s38, 1
  s_waitcnt vmcnt(0)
  v_cmp_ne_u64 vcc, s[26:27], v[162:163]
  s_cmp_gt_u32 s38, 200000
  s_cbranch_scc1 POLL12_X
  s_cbranch_vccz POLL12_X
  s_sleep 16
  s_branch POLL12

POLL12_X:
  s_mov_b64 exec, -1
NW8_11:
  s_mov_b64 exec, 1
  ds_add_u32 v14, v15 offset:16
  s_mov_b64 exec, -1
  s_add_u32 s60, s60, 4
  s_setprio 0
  s_mov_b32 s61, 0
SP13:
  ds_read_b32 v13, v14 offset:16
  s_add_u32 s61, s61, 1
  s_waitcnt lgkmcnt(0)
  v_readfirstlane_b32 s52, v13
  s_cmp_gt_u32 s61, 2000000
  s_cbranch_scc1 SP13_X
  s_cmp_ge_u32 s52, s60
  s_cbranch_scc1 SP13_X

  s_sleep 16
  s_branch SP13
SP13_X:
  s_setprio 1
  s_mul_i32 s56, s48, 98304
  s_add_u32 s56, s56, 25165824
  s_lshl_b32 s57, s29, 11
  s_add_u32 s57, s57, s56
  s_lshl_b32 s58, s29, 10
  s_add_u32 s58, s58, s56
  s_add_u32 s58, s58, 8192

  buffer_load_dwordx4 v[16:19], v2, s[32:35], s57 offen sc1
  buffer_load_dwordx4 v[48:51], v2, s[32:35], s57 offen offset:1024 sc1
  buffer_load_dwordx4 v[80:83], v2, s[32:35], s58 offen sc1
  s_add_u32 s57, s57, 12288
  s_add_u32 s58, s58, 12288
  buffer_load_dwordx4 v[20:23], v2, s[32:35], s57 offen sc1
  buffer_load_dwordx4 v[52:55], v2, s[32:35], s57 offen offset:1024 sc1
  buffer_load_dwordx4 v[84:87], v2, s[32:35], s58 offen sc1
  s_add_u32 s57, s57, 12288
  s_add_u32 s58, s58, 12288
  buffer_load_dwordx4 v[24:27], v2, s[32:35], s57 offen sc1
  buffer_load_dwordx4 v[56:59], v2, s[32:35], s57 offen offset:1024 sc1
  buffer_load_dwordx4 v[88:91], v2, s[32:35], s58 offen sc1
  s_add_u32 s57, s57, 12288
  s_add_u32 s58, s58, 12288
  buffer_load_dwordx4 v[28:31], v2, s[32:35], s57 offen sc1
  buffer_load_dwordx4 v[60:63], v2, s[32:35], s57 offen offset:1024 sc1
  buffer_load_dwordx4 v[92:95], v2, s[32:35], s58 offen sc1
  s_add_u32 s57, s57, 12288
  s_add_u32 s58, s58, 12288
  buffer_load_dwordx4 v[32:35], v2, s[32:35], s57 offen sc1
  buffer_load_dwordx4 v[64:67], v2, s[32:35], s57 offen offset:1024 sc1
  buffer_load_dwordx4 v[96:99], v2, s[32:35], s58 offen sc1
  s_add_u32 s57, s57, 12288
  s_add_u32 s58, s58, 12288
  buffer_load_dwordx4 v[36:39], v2, s[32:35], s57 offen sc1
  buffer_load_dwordx4 v[68:71], v2, s[32:35], s57 offen offset:1024 sc1
  buffer_load_dwordx4 v[100:103], v2, s[32:35], s58 offen sc1
  s_add_u32 s57, s57, 12288
  s_add_u32 s58, s58, 12288
  buffer_load_dwordx4 v[40:43], v2, s[32:35], s57 offen sc1
  buffer_load_dwordx4 v[72:75], v2, s[32:35], s57 offen offset:1024 sc1
  buffer_load_dwordx4 v[136:139], v2, s[32:35], s58 offen sc1
  s_add_u32 s57, s57, 12288
  s_add_u32 s58, s58, 12288
  buffer_load_dwordx4 v[44:47], v2, s[32:35], s57 offen sc1
  buffer_load_dwordx4 v[76:79], v2, s[32:35], s57 offen offset:1024 sc1
  buffer_load_dwordx4 v[140:143], v2, s[32:35], s58 offen sc1
  s_waitcnt vmcnt(0)
  v_add_f32 v16, v16, v20
  v_add_f32 v17, v17, v21
  v_add_f32 v18, v18, v22
  v_add_f32 v19, v19, v23
  v_add_f32 v48, v48, v52
  v_add_f32 v49, v49, v53
  v_add_f32 v50, v50, v54
  v_add_f32 v51, v51, v55
  v_add_f32 v80, v80, v84
  v_add_f32 v81, v81, v85
  v_add_f32 v82, v82, v86
  v_add_f32 v83, v83, v87
  v_add_f32 v24, v24, v28
  v_add_f32 v25, v25, v29
  v_add_f32 v26, v26, v30
  v_add_f32 v27, v27, v31
  v_add_f32 v56, v56, v60
  v_add_f32 v57, v57, v61
  v_add_f32 v58, v58, v62
  v_add_f32 v59, v59, v63
  v_add_f32 v88, v88, v92
  v_add_f32 v89, v89, v93
  v_add_f32 v90, v90, v94
  v_add_f32 v91, v91, v95
  v_add_f32 v32, v32, v36
  v_add_f32 v33, v33, v37
  v_add_f32 v34, v34, v38
  v_add_f32 v35, v35, v39
  v_add_f32 v64, v64, v68
  v_add_f32 v65, v65, v69
  v_add_f32 v66, v66, v70
  v_add_f32 v67, v67, v71
  v_add_f32 v96, v96, v100
  v_add_f32 v97, v97, v101
  v_add_f32 v98, v98, v102
  v_add_f32 v99, v99, v103
  v_add_f32 v40, v40, v44
  v_add_f32 v41, v41, v45
  v_add_f32 v42, v42, v46
  v_add_f32 v43, v43, v47
  v_add_f32 v72, v72, v76
  v_add_f32 v73, v73, v77
  v_add_f32 v74, v74, v78
  v_add_f32 v75, v75, v79
  v_add_f32 v136, v136, v140
  v_add_f32 v137, v137, v141
  v_add_f32 v138, v138, v142
  v_add_f32 v139, v139, v143
  v_add_f32 v16, v16, v24
  v_add_f32 v17, v17, v25
  v_add_f32 v18, v18, v26
  v_add_f32 v19, v19, v27
  v_add_f32 v48, v48, v56
  v_add_f32 v49, v49, v57
  v_add_f32 v50, v50, v58
  v_add_f32 v51, v51, v59
  v_add_f32 v80, v80, v88
  v_add_f32 v81, v81, v89
  v_add_f32 v82, v82, v90
  v_add_f32 v83, v83, v91
  v_add_f32 v32, v32, v40
  v_add_f32 v33, v33, v41
  v_add_f32 v34, v34, v42
  v_add_f32 v35, v35, v43
  v_add_f32 v64, v64, v72
  v_add_f32 v65, v65, v73
  v_add_f32 v66, v66, v74
  v_add_f32 v67, v67, v75
  v_add_f32 v96, v96, v136
  v_add_f32 v97, v97, v137
  v_add_f32 v98, v98, v138
  v_add_f32 v99, v99, v139
  v_add_f32 v16, v16, v32
  v_add_f32 v17, v17, v33
  v_add_f32 v18, v18, v34
  v_add_f32 v19, v19, v35
  v_add_f32 v48, v48, v64
  v_add_f32 v49, v49, v65
  v_add_f32 v50, v50, v66
  v_add_f32 v51, v51, v67
  v_add_f32 v80, v80, v96
  v_add_f32 v81, v81, v97
  v_add_f32 v82, v82, v98
  v_add_f32 v83, v83, v99
  v_cvt_pk_bf16_f32 v144, v16, v17
  v_cvt_pk_bf16_f32 v145, v18, v19
  v_cvt_pk_bf16_f32 v146, v48, v49
  v_cvt_pk_bf16_f32 v147, v50, v51
  v_cvt_pk_bf16_f32 v148, v80, v81
  v_cvt_pk_bf16_f32 v149, v82, v83
  ds_write_b64 v6, v[144:145]
  ds_write_b64 v6, v[146:147] offset:1024
  s_lshr_b32 s56, s29, 1
  s_lshl_b32 s56, s56, 10
  s_sub_u32 s56, 4096, s56
  v_add_u32 v10, s56, v6
  ds_write_b64 v10, v[148:149]
  s_waitcnt lgkmcnt(0)

  s_mov_b64 exec, 1
  ds_add_u32 v14, v15 offset:16
  s_mov_b64 exec, -1
  s_add_u32 s60, s60, 4
  s_setprio 0
  s_mov_b32 s61, 0
SP14:
  ds_read_b32 v13, v14 offset:16
  s_add_u32 s61, s61, 1
  s_waitcnt lgkmcnt(0)
  v_readfirstlane_b32 s52, v13
  s_cmp_gt_u32 s61, 2000000
  s_cbranch_scc1 SP14_X
  s_cmp_ge_u32 s52, s60
  s_cbranch_scc1 SP14_X

  s_sleep 16
  s_branch SP14
SP14_X:
  s_setprio 1
  ds_read_b128 v[16:19], v7 offset:0
  ds_read_b128 v[20:23], v7 offset:128
  ds_read_b128 v[24:27], v7 offset:2048
  ds_read_b128 v[28:31], v7 offset:2176
  ds_read_b128 v[32:35], v9 offset:4096
  ds_read_b128 v[36:39], v9 offset:5120
  v_mov_b32 v40, 0x3f803f80
  v_mov_b32 v41, 0x3f803f80
  v_mov_b32 v42, 0x3f803f80
  v_mov_b32 v43, 0x3f803f80
  s_lshl_b32 s56, s49, 4
  s_lshl_b32 s57, s29, 2
  s_add_u32 s56, s56, s57
  s_lshl_b32 s56, s56, 5
  s_add_u32 s56, s56, s48
  s_lshl_b32 s56, s56, 10
  s_add_u32 s56, s56, 33554432
  s_waitcnt lgkmcnt(0)

  v_mfma_f32_16x16x32_bf16 v[60:63], v[32:35], v[104:107], 0
  v_mfma_f32_16x16x32_bf16 v[136:139], v[40:43], v[104:107], 0
  v_mfma_f32_16x16x32_bf16 v[44:47], v[16:19], v[104:107], 0
  v_mfma_f32_16x16x32_bf16 v[48:51], v[20:23], v[104:107], 0
  v_mfma_f32_16x16x32_bf16 v[64:67], v[36:39], v[108:111], 0
  v_mfma_f32_16x16x32_bf16 v[140:143], v[40:43], v[108:111], 0
  v_mfma_f32_16x16x32_bf16 v[52:55], v[24:27], v[108:111], 0
  v_mfma_f32_16x16x32_bf16 v[56:59], v[28:31], v[108:111], 0
  v_mfma_f32_16x16x32_bf16 v[88:91], v[32:35], v[112:115], 0
  v_mfma_f32_16x16x32_bf16 v[144:147], v[40:43], v[112:115], 0
  v_mfma_f32_16x16x32_bf16 v[72:75], v[16:19], v[112:115], 0
  v_mfma_f32_16x16x32_bf16 v[76:79], v[20:23], v[112:115], 0
  v_mfma_f32_16x16x32_bf16 v[92:95], v[36:39], v[116:119], 0
  v_mfma_f32_16x16x32_bf16 v[148:151], v[40:43], v[116:119], 0
  v_mfma_f32_16x16x32_bf16 v[80:83], v[24:27], v[116:119], 0
  v_mfma_f32_16x16x32_bf16 v[84:87], v[28:31], v[116:119], 0
  v_rcp_f32 v10, v136
  v_rcp_f32 v11, v140
  v_mov_b32 v12, 897988541
  v_fmac_f32 v12, v10, v60
  v_fmac_f32 v12, v11, v64
  v_rcp_f32 v12, v12
  s_nop 0
  v_mul_f32 v10, v12, v10
  v_mul_f32 v11, v12, v11

  v_mul_f32 v44, v10, v44
  v_mul_f32 v45, v10, v45
  v_mul_f32 v46, v10, v46
  v_mul_f32 v47, v10, v47
  v_mul_f32 v48, v10, v48
  v_mul_f32 v49, v10, v49
  v_mul_f32 v50, v10, v50
  v_mul_f32 v51, v10, v51
  v_fmac_f32 v44, v11, v52
  v_fmac_f32 v45, v11, v53
  v_fmac_f32 v46, v11, v54
  v_fmac_f32 v47, v11, v55
  v_fmac_f32 v48, v11, v56
  v_fmac_f32 v49, v11, v57
  v_fmac_f32 v50, v11, v58
  v_fmac_f32 v51, v11, v59
  v_cvt_pk_bf16_f32 v152, v44, v45
  v_cvt_pk_bf16_f32 v153, v46, v47
  v_cvt_pk_bf16_f32 v154, v48, v49
  v_cvt_pk_bf16_f32 v155, v50, v51
  buffer_store_dwordx4 v[152:155], v2, s[32:35], s56 offen sc1
  s_add_u32 s56, s56, 32768
  v_mfma_f32_16x16x32_bf16 v[60:63], v[32:35], v[120:123], 0
  v_mfma_f32_16x16x32_bf16 v[136:139], v[40:43], v[120:123], 0
  v_mfma_f32_16x16x32_bf16 v[44:47], v[16:19], v[120:123], 0
  v_mfma_f32_16x16x32_bf16 v[48:51], v[20:23], v[120:123], 0
  v_mfma_f32_16x16x32_bf16 v[64:67], v[36:39], v[124:127], 0
  v_mfma_f32_16x16x32_bf16 v[140:143], v[40:43], v[124:127], 0
  v_mfma_f32_16x16x32_bf16 v[52:55], v[24:27], v[124:127], 0
  v_mfma_f32_16x16x32_bf16 v[56:59], v[28:31], v[124:127], 0
  v_rcp_f32 v10, v144
  v_rcp_f32 v11, v148
  v_mov_b32 v12, 897988541
  v_fmac_f32 v12, v10, v88
  v_fmac_f32 v12, v11, v92
  v_rcp_f32 v12, v12
  s_nop 0
  v_mul_f32 v10, v12, v10
  v_mul_f32 v11, v12, v11

  v_mul_f32 v72, v10, v72
  v_mul_f32 v73, v10, v73
  v_mul_f32 v74, v10, v74
  v_mul_f32 v75, v10, v75
  v_mul_f32 v76, v10, v76
  v_mul_f32 v77, v10, v77
  v_mul_f32 v78, v10, v78
  v_mul_f32 v79, v10, v79
  v_fmac_f32 v72, v11, v80
  v_fmac_f32 v73, v11, v81
  v_fmac_f32 v74, v11, v82
  v_fmac_f32 v75, v11, v83
  v_fmac_f32 v76, v11, v84
  v_fmac_f32 v77, v11, v85
  v_fmac_f32 v78, v11, v86
  v_fmac_f32 v79, v11, v87
  v_cvt_pk_bf16_f32 v156, v72, v73
  v_cvt_pk_bf16_f32 v157, v74, v75
  v_cvt_pk_bf16_f32 v158, v76, v77
  v_cvt_pk_bf16_f32 v159, v78, v79
  buffer_store_dwordx4 v[156:159], v2, s[32:35], s56 offen sc1
  s_add_u32 s56, s56, 32768
  v_mfma_f32_16x16x32_bf16 v[88:91], v[32:35], v[128:131], 0
  v_mfma_f32_16x16x32_bf16 v[144:147], v[40:43], v[128:131], 0
  v_mfma_f32_16x16x32_bf16 v[72:75], v[16:19], v[128:131], 0
  v_mfma_f32_16x16x32_bf16 v[76:79], v[20:23], v[128:131], 0
  v_mfma_f32_16x16x32_bf16 v[92:95], v[36:39], v[132:135], 0
  v_mfma_f32_16x16x32_bf16 v[148:151], v[40:43], v[132:135], 0
  v_mfma_f32_16x16x32_bf16 v[80:83], v[24:27], v[132:135], 0
  v_mfma_f32_16x16x32_bf16 v[84:87], v[28:31], v[132:135], 0
  v_rcp_f32 v10, v136
  v_rcp_f32 v11, v140
  v_mov_b32 v12, 897988541
  v_fmac_f32 v12, v10, v60
  v_fmac_f32 v12, v11, v64
  v_rcp_f32 v12, v12
  s_nop 0
  v_mul_f32 v10, v12, v10
  v_mul_f32 v11, v12, v11

  v_mul_f32 v44, v10, v44
  v_mul_f32 v45, v10, v45
  v_mul_f32 v46, v10, v46
  v_mul_f32 v47, v10, v47
  v_mul_f32 v48, v10, v48
  v_mul_f32 v49, v10, v49
  v_mul_f32 v50, v10, v50
  v_mul_f32 v51, v10, v51
  v_fmac_f32 v44, v11, v52
  v_fmac_f32 v45, v11, v53
  v_fmac_f32 v46, v11, v54
  v_fmac_f32 v47, v11, v55
  v_fmac_f32 v48, v11, v56
  v_fmac_f32 v49, v11, v57
  v_fmac_f32 v50, v11, v58
  v_fmac_f32 v51, v11, v59
  v_cvt_pk_bf16_f32 v152, v44, v45
  v_cvt_pk_bf16_f32 v153, v46, v47
  v_cvt_pk_bf16_f32 v154, v48, v49
  v_cvt_pk_bf16_f32 v155, v50, v51
  buffer_store_dwordx4 v[152:155], v2, s[32:35], s56 offen sc1
  s_add_u32 s56, s56, 32768
  s_nop 1
  v_rcp_f32 v10, v144
  v_rcp_f32 v11, v148
  v_mov_b32 v12, 897988541
  v_fmac_f32 v12, v10, v88
  v_fmac_f32 v12, v11, v92
  v_rcp_f32 v12, v12
  s_nop 0
  v_mul_f32 v10, v12, v10
  v_mul_f32 v11, v12, v11

  v_mul_f32 v72, v10, v72
  v_mul_f32 v73, v10, v73
  v_mul_f32 v74, v10, v74
  v_mul_f32 v75, v10, v75
  v_mul_f32 v76, v10, v76
  v_mul_f32 v77, v10, v77
  v_mul_f32 v78, v10, v78
  v_mul_f32 v79, v10, v79
  v_fmac_f32 v72, v11, v80
  v_fmac_f32 v73, v11, v81
  v_fmac_f32 v74, v11, v82
  v_fmac_f32 v75, v11, v83
  v_fmac_f32 v76, v11, v84
  v_fmac_f32 v77, v11, v85
  v_fmac_f32 v78, v11, v86
  v_fmac_f32 v79, v11, v87
  v_cvt_pk_bf16_f32 v156, v72, v73
  v_cvt_pk_bf16_f32 v157, v74, v75
  v_cvt_pk_bf16_f32 v158, v76, v77
  v_cvt_pk_bf16_f32 v159, v78, v79
  buffer_store_dwordx4 v[156:159], v2, s[32:35], s56 offen sc1
  s_add_u32 s56, s56, 32768
  s_waitcnt vmcnt(0)
  s_mov_b64 exec, 1
  ds_add_u32 v14, v15 offset:16
  s_mov_b64 exec, -1
  s_add_u32 s60, s60, 4
  s_setprio 0
  s_mov_b32 s61, 0
SP15:
  ds_read_b32 v13, v14 offset:16
  s_add_u32 s61, s61, 1
  s_waitcnt lgkmcnt(0)
  v_readfirstlane_b32 s52, v13
  s_cmp_gt_u32 s61, 2000000
  s_cbranch_scc1 SP15_X
  s_cmp_ge_u32 s52, s60
  s_cbranch_scc1 SP15_X

  s_sleep 16
  s_branch SP15
SP15_X:
  s_setprio 1
  s_lshl_b32 s56, s49, 5
  s_add_u32 s56, s56, s48
  s_lshl_b32 s56, s56, 7
  s_add_u32 s56, s56, 37814272
  s_add_u32 s57, s56, 32768
  s_mov_b32 s64, s56

  s_cmp_lg_u32 s24, 8
  s_cbranch_scc1 NW8_16
  v_mov_b32 v160, 0
  v_mov_b32 v162, s26
  v_mov_b32 v163, s27
  s_mov_b64 exec, 1

  buffer_store_dwordx2 v[162:163], v160, s[32:35], s57 offen sc0 sc1
  s_mov_b64 exec, -1
NW8_16:
  s_add_u32 s48, s48, 1
  s_and_b32 s56, s48, 1
  s_cbranch_scc1 P2_AUXL

P2_AUXE:
  s_and_b32 s60, s2, 7
  s_lshr_b32 s61, s2, 3
  s_lshr_b32 s48, s60, 2
  s_lshr_b32 s49, s60, 1
  s_and_b32 s49, s49, 1
  s_lshl_b32 s49, s49, 3
  s_and_b32 s62, s61, 7
  s_add_u32 s49, s49, s62
  s_and_b32 s50, s60, 1
  s_lshl_b32 s50, s50, 2
  s_lshr_b32 s62, s61, 3
  s_add_u32 s50, s50, s62

  s_cmp_eq_u32 s48, 0
  s_cselect_b64 s[38:39], s[8:9], s[16:17]
  v_lshrrev_b32 v10, 2, v1
  v_lshlrev_b32 v10, 3, v10
  s_and_b32 s60, s49, 7
  v_add_u32 v10, s60, v10
  v_lshlrev_b32 v10, 11, v10
  v_and_b32 v11, 3, v1
  v_lshl_add_u32 v10, v11, 6, v10
  s_lshl_b32 s60, s50, 8
  s_lshl_b32 s61, s29, 19
  s_add_u32 s60, s60, s61
  s_add_u32 s61, s60, 262144

  s_mov_b32 s40, s38
  s_and_b32 s41, s39, 0xffff
  s_mov_b32 s42, 2097152
  s_mov_b32 s43, 0x20000
  buffer_load_dword v166, v10, s[40:43], s60 offen
  buffer_load_dword v167, v10, s[40:43], s61 offen
  s_setprio 0
  s_and_b32 s60, s2, 7
  s_lshr_b32 s61, s2, 3
  s_lshr_b32 s48, s60, 2
  s_lshr_b32 s49, s60, 1
  s_and_b32 s49, s49, 1
  s_lshl_b32 s49, s49, 3
  s_and_b32 s62, s61, 7
  s_add_u32 s49, s49, s62
  s_and_b32 s50, s60, 1
  s_lshl_b32 s50, s50, 2
  s_lshr_b32 s62, s61, 3
  s_add_u32 s50, s50, s62

  s_lshl_b32 s54, s49, 3
  s_lshl_b32 s60, s29, 1
  s_add_u32 s54, s54, s60
  s_lshl_b32 s54, s54, 15
  s_lshl_b32 s60, s48, 22
  s_add_u32 s54, s54, s60
  s_add_u32 s54, s54, 29360128
  s_lshl_b32 s56, s29, 12
  s_add_u32 s57, s56, 65536
  s_lshl_b32 s55, s29, 15
  s_lshl_b32 s60, s50, 8
  s_add_u32 s55, s55, s60
  v_add_u32 v3, 30720, v2
  v_lshrrev_b32 v10, 4, v1
  v_lshlrev_b32 v11, 1, v10
  v_and_b32 v12, 15, v1
  v_xor_b32 v11, v11, v12
  v_lshlrev_b32 v11, 4, v11
  v_lshl_add_u32 v4, v10, 11, v11
  v_xor_b32 v5, 128, v4
  v_add_u32 v5, 7168, v5
  v_add_u32 v6, 14336, v4
  v_add_u32 v7, 14336, v5
  s_lshr_b32 s60, s49, 1
  s_lshl_b32 s60, s60, 12
  s_lshl_b32 s61, s48, 15
  s_add_u32 s60, s60, s61
  s_add_u32 s60, s60, 37814272
  v_lshlrev_b32 v8, 7, v1
  v_add_u32 v8, s60, v8

  s_cmp_eq_u32 s48, 0
  s_cselect_b64 s[38:39], s[8:9], s[16:17]

  s_mov_b32 s40, s38
  s_and_b32 s41, s39, 0xffff
  s_mov_b32 s42, 2097152
  s_mov_b32 s43, 0x20000
  s_mov_b32 s68, s22
  s_and_b32 s69, s23, 0xffff
  s_mov_b32 s70, 38797312
  s_mov_b32 s71, 0x20000
  s_add_u32 m0, s57, 0
  s_nop 0
  buffer_load_dwordx4 v4, s[40:43], s55 offen offset:0 lds
  buffer_load_dwordx4 v5, s[40:43], s55 offen offset:1024 lds
  buffer_load_dwordx4 v6, s[40:43], s55 offen offset:2048 lds
  buffer_load_dwordx4 v7, s[40:43], s55 offen offset:3072 lds
  s_add_u32 s55, s55, 131072
  s_add_u32 m0, s57, 16384
  s_nop 0
  buffer_load_dwordx4 v4, s[40:43], s55 offen offset:0 lds
  buffer_load_dwordx4 v5, s[40:43], s55 offen offset:1024 lds
  buffer_load_dwordx4 v6, s[40:43], s55 offen offset:2048 lds
  buffer_load_dwordx4 v7, s[40:43], s55 offen offset:3072 lds
  s_add_u32 s55, s55, 131072
  s_add_u32 m0, s57, 32768
  s_nop 0
  buffer_load_dwordx4 v4, s[40:43], s55 offen offset:0 lds
  buffer_load_dwordx4 v5, s[40:43], s55 offen offset:1024 lds
  buffer_load_dwordx4 v6, s[40:43], s55 offen offset:2048 lds
  buffer_load_dwordx4 v7, s[40:43], s55 offen offset:3072 lds
  s_add_u32 s55, s55, 131072
  s_add_u32 m0, s57, 49152
  s_nop 0
  buffer_load_dwordx4 v4, s[40:43], s55 offen offset:0 lds
  buffer_load_dwordx4 v5, s[40:43], s55 offen offset:1024 lds
  buffer_load_dwordx4 v6, s[40:43], s55 offen offset:2048 lds
  buffer_load_dwordx4 v7, s[40:43], s55 offen offset:3072 lds
  s_add_u32 s55, s55, 131072
  s_cmp_lg_u32 s24, 8
  s_cbranch_scc1 NW8_17
  s_mov_b32 s36, 4294967295
  s_mov_b32 s37, 0
  s_mov_b64 exec, s[36:37]
  s_mov_b32 s38, 0

POLL18:
  buffer_load_dwordx2 v[162:163], v8, s[32:35], 0 offen sc0 sc1
  s_add_u32 s38, s38, 1
  s_waitcnt vmcnt(0)
  v_cmp_ne_u64 vcc, s[26:27], v[162:163]
  s_cmp_gt_u32 s38, 200000
  s_cbranch_scc1 POLL18_X
  s_cbranch_vccz POLL18_X
  s_sleep 2
  s_branch POLL18

POLL18_X:
  s_mov_b64 exec, -1
NW8_17:
  s_barrier
  s_setprio 3
  s_add_u32 m0, s56, 0
  s_nop 0
  buffer_load_dwordx4 v2, s[68:71], s54 offen offset:0 sc1 lds
  buffer_load_dwordx4 v2, s[68:71], s54 offen offset:1024 sc1 lds
  buffer_load_dwordx4 v3, s[68:71], s54 offen offset:2048 sc1 lds
  buffer_load_dwordx4 v3, s[68:71], s54 offen offset:3072 sc1 lds
  s_add_u32 s54, s54, 2048
  s_add_u32 m0, s56, 16384
  s_nop 0
  buffer_load_dwordx4 v2, s[68:71], s54 offen offset:0 sc1 lds
  buffer_load_dwordx4 v2, s[68:71], s54 offen offset:1024 sc1 lds
  buffer_load_dwordx4 v3, s[68:71], s54 offen offset:2048 sc1 lds
  buffer_load_dwordx4 v3, s[68:71], s54 offen offset:3072 sc1 lds
  s_add_u32 s54, s54, 2048
  s_add_u32 m0, s56, 32768
  s_nop 0
  buffer_load_dwordx4 v2, s[68:71], s54 offen offset:0 sc1 lds
  buffer_load_dwordx4 v2, s[68:71], s54 offen offset:1024 sc1 lds
  buffer_load_dwordx4 v3, s[68:71], s54 offen offset:2048 sc1 lds
  buffer_load_dwordx4 v3, s[68:71], s54 offen offset:3072 sc1 lds
  s_add_u32 s54, s54, 2048
  s_add_u32 m0, s56, 49152
  s_nop 0
  buffer_load_dwordx4 v2, s[68:71], s54 offen offset:0 sc1 lds
  buffer_load_dwordx4 v2, s[68:71], s54 offen offset:1024 sc1 lds
  buffer_load_dwordx4 v3, s[68:71], s54 offen offset:2048 sc1 lds
  buffer_load_dwordx4 v3, s[68:71], s54 offen offset:3072 sc1 lds
  s_add_u32 s54, s54, 2048
  s_waitcnt vmcnt(12)
  s_barrier
  s_waitcnt vmcnt(8)
  s_barrier
  s_add_u32 m0, s56, 0
  s_nop 0
  buffer_load_dwordx4 v2, s[68:71], s54 offen offset:0 sc1 lds
  buffer_load_dwordx4 v2, s[68:71], s54 offen offset:1024 sc1 lds
  buffer_load_dwordx4 v3, s[68:71], s54 offen offset:2048 sc1 lds
  buffer_load_dwordx4 v3, s[68:71], s54 offen offset:3072 sc1 lds
  s_add_u32 s54, s54, 2048
  s_add_u32 m0, s57, 0
  s_nop 0
  buffer_load_dwordx4 v4, s[40:43], s55 offen offset:0 lds
  buffer_load_dwordx4 v5, s[40:43], s55 offen offset:1024 lds
  buffer_load_dwordx4 v6, s[40:43], s55 offen offset:2048 lds
  buffer_load_dwordx4 v7, s[40:43], s55 offen offset:3072 lds
  s_add_u32 s55, s55, 131072
  s_waitcnt vmcnt(12)
  s_barrier
  s_add_u32 m0, s56, 16384
  s_nop 0
  buffer_load_dwordx4 v2, s[68:71], s54 offen offset:0 sc1 lds
  buffer_load_dwordx4 v2, s[68:71], s54 offen offset:1024 sc1 lds
  buffer_load_dwordx4 v3, s[68:71], s54 offen offset:2048 sc1 lds
  buffer_load_dwordx4 v3, s[68:71], s54 offen offset:3072 sc1 lds
  s_add_u32 s54, s54, 2048
  s_add_u32 m0, s57, 16384
  s_nop 0
  buffer_load_dwordx4 v4, s[40:43], s55 offen offset:0 lds
  buffer_load_dwordx4 v5, s[40:43], s55 offen offset:1024 lds
  buffer_load_dwordx4 v6, s[40:43], s55 offen offset:2048 lds
  buffer_load_dwordx4 v7, s[40:43], s55 offen offset:3072 lds
  s_add_u32 s55, s55, 131072
  s_waitcnt vmcnt(16)
  s_barrier
  s_add_u32 m0, s56, 32768
  s_nop 0
  buffer_load_dwordx4 v2, s[68:71], s54 offen offset:0 sc1 lds
  buffer_load_dwordx4 v2, s[68:71], s54 offen offset:1024 sc1 lds
  buffer_load_dwordx4 v3, s[68:71], s54 offen offset:2048 sc1 lds
  buffer_load_dwordx4 v3, s[68:71], s54 offen offset:3072 sc1 lds
  s_add_u32 s54, s54, 2048
  s_add_u32 m0, s57, 32768
  s_nop 0
  buffer_load_dwordx4 v4, s[40:43], s55 offen offset:0 lds
  buffer_load_dwordx4 v5, s[40:43], s55 offen offset:1024 lds
  buffer_load_dwordx4 v6, s[40:43], s55 offen offset:2048 lds
  buffer_load_dwordx4 v7, s[40:43], s55 offen offset:3072 lds
  s_add_u32 s55, s55, 131072
  s_mov_b32 s58, 4
P3_LDL:
  s_cmp_lt_u32 s58, 13
  s_cselect_b32 s70, 38797312, 0
  s_add_u32 s58, s58, 1
  s_waitcnt vmcnt(16)
  s_barrier

  s_add_u32 m0, s56, 49152
  s_nop 0
  buffer_load_dwordx4 v2, s[68:71], s54 offen offset:0 sc1 lds
  buffer_load_dwordx4 v2, s[68:71], s54 offen offset:1024 sc1 lds
  buffer_load_dwordx4 v3, s[68:71], s54 offen offset:2048 sc1 lds
  buffer_load_dwordx4 v3, s[68:71], s54 offen offset:3072 sc1 lds
  s_add_u32 s54, s54, 2048
  s_add_u32 m0, s57, 49152
  s_nop 0
  buffer_load_dwordx4 v4, s[40:43], s55 offen offset:0 lds
  buffer_load_dwordx4 v5, s[40:43], s55 offen offset:1024 lds
  buffer_load_dwordx4 v6, s[40:43], s55 offen offset:2048 lds
  buffer_load_dwordx4 v7, s[40:43], s55 offen offset:3072 lds
  s_add_u32 s55, s55, 131072
  s_cmp_lt_u32 s58, 13
  s_cselect_b32 s70, 38797312, 0
  s_add_u32 s58, s58, 1
  s_waitcnt vmcnt(16)
  s_barrier

  s_add_u32 m0, s56, 0
  s_nop 0
  buffer_load_dwordx4 v2, s[68:71], s54 offen offset:0 sc1 lds
  buffer_load_dwordx4 v2, s[68:71], s54 offen offset:1024 sc1 lds
  buffer_load_dwordx4 v3, s[68:71], s54 offen offset:2048 sc1 lds
  buffer_load_dwordx4 v3, s[68:71], s54 offen offset:3072 sc1 lds
  s_add_u32 s54, s54, 2048
  s_add_u32 m0, s57, 0
  s_nop 0
  buffer_load_dwordx4 v4, s[40:43], s55 offen offset:0 lds
  buffer_load_dwordx4 v5, s[40:43], s55 offen offset:1024 lds
  buffer_load_dwordx4 v6, s[40:43], s55 offen offset:2048 lds
  buffer_load_dwordx4 v7, s[40:43], s55 offen offset:3072 lds
  s_add_u32 s55, s55, 131072
  s_cmp_lt_u32 s58, 13
  s_cselect_b32 s70, 38797312, 0
  s_add_u32 s58, s58, 1
  s_waitcnt vmcnt(16)
  s_barrier

  s_add_u32 m0, s56, 16384
  s_nop 0
  buffer_load_dwordx4 v2, s[68:71], s54 offen offset:0 sc1 lds
  buffer_load_dwordx4 v2, s[68:71], s54 offen offset:1024 sc1 lds
  buffer_load_dwordx4 v3, s[68:71], s54 offen offset:2048 sc1 lds
  buffer_load_dwordx4 v3, s[68:71], s54 offen offset:3072 sc1 lds
  s_add_u32 s54, s54, 2048
  s_add_u32 m0, s57, 16384
  s_nop 0
  buffer_load_dwordx4 v4, s[40:43], s55 offen offset:0 lds
  buffer_load_dwordx4 v5, s[40:43], s55 offen offset:1024 lds
  buffer_load_dwordx4 v6, s[40:43], s55 offen offset:2048 lds
  buffer_load_dwordx4 v7, s[40:43], s55 offen offset:3072 lds
  s_add_u32 s55, s55, 131072
  s_cmp_lt_u32 s58, 13
  s_cselect_b32 s70, 38797312, 0
  s_add_u32 s58, s58, 1
  s_waitcnt vmcnt(16)
  s_barrier

  s_add_u32 m0, s56, 32768
  s_nop 0
  buffer_load_dwordx4 v2, s[68:71], s54 offen offset:0 sc1 lds
  buffer_load_dwordx4 v2, s[68:71], s54 offen offset:1024 sc1 lds
  buffer_load_dwordx4 v3, s[68:71], s54 offen offset:2048 sc1 lds
  buffer_load_dwordx4 v3, s[68:71], s54 offen offset:3072 sc1 lds
  s_add_u32 s54, s54, 2048
  s_add_u32 m0, s57, 32768
  s_nop 0
  buffer_load_dwordx4 v4, s[40:43], s55 offen offset:0 lds
  buffer_load_dwordx4 v5, s[40:43], s55 offen offset:1024 lds
  buffer_load_dwordx4 v6, s[40:43], s55 offen offset:2048 lds
  buffer_load_dwordx4 v7, s[40:43], s55 offen offset:3072 lds
  s_add_u32 s55, s55, 131072
  s_cmp_lt_u32 s58, 16
  s_cbranch_scc1 P3_LDL
  s_waitcnt vmcnt(0)
  s_barrier

  s_endpgm
COMP:
  s_and_b32 s64, s2, 7
  s_lshr_b32 s65, s2, 3
  s_lshr_b32 s48, s65, 4
  s_and_b32 s49, s64, 4
  s_and_b32 s66, s65, 3
  s_add_u32 s49, s49, s66
  s_and_b32 s50, s64, 3
  s_lshl_b32 s50, s50, 2
  s_bfe_u32 s66, s65, 0x20002
  s_add_u32 s50, s50, s66

  s_cmp_lg_u32 s24, 6
  s_cbranch_scc1 NW8_19
  s_getpc_b64 s[36:37]
PC_HERE:
  s_sub_u32 s36, s36, PC_HERE-CODE_BEG
  s_subb_u32 s37, s37, 0
  v_lshlrev_b32 v160, 6, v1
  s_mov_b32 s38, CODE_END-CODE_BEG-4

  v_min_u32 v161, s38, v160
  global_load_dword v162, v161, s[36:37]
  v_add_u32 v160, 4096, v160
  v_min_u32 v161, s38, v160
  global_load_dword v162, v161, s[36:37]
  v_add_u32 v160, 4096, v160
  v_min_u32 v161, s38, v160
  global_load_dword v162, v161, s[36:37]
  v_add_u32 v160, 4096, v160
  v_min_u32 v161, s38, v160
  global_load_dword v162, v161, s[36:37]
  v_add_u32 v160, 4096, v160
  v_min_u32 v161, s38, v160
  global_load_dword v162, v161, s[36:37]
  v_add_u32 v160, 4096, v160
  v_min_u32 v161, s38, v160
  global_load_dword v162, v161, s[36:37]
  v_add_u32 v160, 4096, v160
NW8_19:
  v_mov_b32 v3, 163776
  v_mov_b32 v4, 1
  s_mov_b32 s68, 0
  s_and_b32 s51, s24, 3
  s_lshr_b32 s52, s24, 2
  s_lshl_b32 s53, s50, 1
  s_add_u32 s53, s53, s52
  s_mov_b32 s63, 1048744942
  v_and_b32 v10, 15, v1
  s_lshl_b32 s64, s51, 6
  v_add_u32 v11, s64, v10
  v_lshlrev_b32 v11, 7, v11
  v_lshrrev_b32 v10, 1, v10
  v_lshrrev_b32 v12, 4, v1
  v_xor_b32 v10, v10, v12
  v_lshl_add_u32 v6, v10, 4, v11
  v_xor_b32 v7, 64, v6
  v_lshrrev_b32 v10, 4, v1
  v_bfe_u32 v11, v1, 2, 2
  v_lshl_add_u32 v12, v10, 3, v11
  v_lshlrev_b32 v12, 7, v12
  v_lshrrev_b32 v11, 1, v11
  v_and_b32 v10, 1, v10
  v_lshl_add_u32 v11, v10, 1, v11
  s_lshl_b32 s64, s52, 1
  v_xor_b32 v11, s64, v11
  v_lshl_add_u32 v12, v11, 5, v12
  v_and_b32 v11, 3, v1
  v_lshl_add_u32 v12, v11, 3, v12
  v_add_u32 v8, 98304, v12
  v_xor_b32 v9, 32, v8

  v_mov_b32 v64, 0
  v_mov_b32 v65, 0
  v_mov_b32 v66, 0
  v_mov_b32 v67, 0
  v_mov_b32 v68, 0
  v_mov_b32 v69, 0
  v_mov_b32 v70, 0
  v_mov_b32 v71, 0
  v_mov_b32 v72, 0
  v_mov_b32 v73, 0
  v_mov_b32 v74, 0
  v_mov_b32 v75, 0
  v_mov_b32 v76, 0
  v_mov_b32 v77, 0
  v_mov_b32 v78, 0
  v_mov_b32 v79, 0
  v_mov_b32 v80, 0
  v_mov_b32 v81, 0
  v_mov_b32 v82, 0
  v_mov_b32 v83, 0
  v_mov_b32 v84, 0
  v_mov_b32 v85, 0
  v_mov_b32 v86, 0
  v_mov_b32 v87, 0
  v_mov_b32 v88, 0
  v_mov_b32 v89, 0
  v_mov_b32 v90, 0
  v_mov_b32 v91, 0
  v_mov_b32 v92, 0
  v_mov_b32 v93, 0
  v_mov_b32 v94, 0
  v_mov_b32 v95, 0
  v_mov_b32 v96, 0
  v_mov_b32 v97, 0
  v_mov_b32 v98, 0
  v_mov_b32 v99, 0
  v_mov_b32 v100, 0
  v_mov_b32 v101, 0
  v_mov_b32 v102, 0
  v_mov_b32 v103, 0
  v_mov_b32 v104, 0
  v_mov_b32 v105, 0
  v_mov_b32 v106, 0
  v_mov_b32 v107, 0
  v_mov_b32 v108, 0
  v_mov_b32 v109, 0
  v_mov_b32 v110, 0
  v_mov_b32 v111, 0
  v_mov_b32 v112, 0
  v_mov_b32 v113, 0
  v_mov_b32 v114, 0
  v_mov_b32 v115, 0
  v_mov_b32 v116, 0
  v_mov_b32 v117, 0
  v_mov_b32 v118, 0
  v_mov_b32 v119, 0
  v_mov_b32 v120, 0
  v_mov_b32 v121, 0
  v_mov_b32 v122, 0
  v_mov_b32 v123, 0
  v_mov_b32 v124, 0
  v_mov_b32 v125, 0
  v_mov_b32 v126, 0
  v_mov_b32 v127, 0
  v_mov_b32 v128, 0
  v_mov_b32 v129, 0
  v_mov_b32 v130, 0
  v_mov_b32 v131, 0
  v_mov_b32 v132, 0
  v_mov_b32 v133, 0
  v_mov_b32 v134, 0
  v_mov_b32 v135, 0
  v_mov_b32 v136, 0
  v_mov_b32 v137, 0
  v_mov_b32 v138, 0
  v_mov_b32 v139, 0
  v_mov_b32 v140, 0
  v_mov_b32 v141, 0
  v_mov_b32 v142, 0
  v_mov_b32 v143, 0
  v_mov_b32 v144, 0
  v_mov_b32 v145, 0
  v_mov_b32 v146, 0
  v_mov_b32 v147, 0
  v_mov_b32 v148, 0
  v_mov_b32 v149, 0
  v_mov_b32 v150, 0
  v_mov_b32 v151, 0
  v_mov_b32 v152, 0
  v_mov_b32 v153, 0
  v_mov_b32 v154, 0
  v_mov_b32 v155, 0
  v_mov_b32 v156, 0
  v_mov_b32 v157, 0
  v_mov_b32 v158, 0
  v_mov_b32 v159, 0
  s_waitcnt lgkmcnt(0)
  s_mov_b32 s32, s22
  s_and_b32 s33, s23, 0xffff
  s_mov_b32 s34, 38797312
  s_mov_b32 s35, 0x20000
  s_cmp_lg_u32 s24, 7
  s_cbranch_scc1 NW8_20
  s_cmp_lg_u32 s2, 0
  s_cbranch_scc1 NN21
  s_memrealtime s[26:27]
  v_mov_b32 v160, 0
  s_waitcnt lgkmcnt(0)
  s_or_b32 s26, s26, 1
  v_mov_b32 v164, s26
  v_mov_b32 v165, s27
  s_mov_b64 exec, 1
  global_store_dwordx2 v160, v[164:165], s[20:21] sc0 sc1
  s_mov_b64 exec, -1

NN21:
NW8_20:
  s_barrier
  ds_read_b128 v[16:19], v6 offset:0
  ds_read_b128 v[20:23], v6 offset:2048
  ds_read_b128 v[24:27], v6 offset:4096
  ds_read_b128 v[28:31], v6 offset:6144
  ds_read_b64_tr_b16 v[48:49], v8 offset:0
  ds_read_b64_tr_b16 v[50:51], v8 offset:512
  ds_read_b64_tr_b16 v[52:53], v9 offset:0
  ds_read_b64_tr_b16 v[54:55], v9 offset:512
  ds_read_b64_tr_b16 v[56:57], v8 offset:4096
  ds_read_b64_tr_b16 v[58:59], v8 offset:4608
  s_mov_b32 s58, 0
  s_mov_b32 s59, 0
  s_waitcnt lgkmcnt(0)

P1_LOOP:
  s_add_u32 s67, s59, 32768
  s_cmp_eq_u32 s67, 98304
  s_cselect_b32 s67, 0, s67
  s_sub_u32 s62, s67, s59

  s_waitcnt lgkmcnt(8)
  s_waitcnt lgkmcnt(7)
  v_mfma_f32_16x16x32_bf16 v[64:67], v[48:51], v[16:19], v[64:67]
  ds_read_b64_tr_b16 v[60:61], v9 offset:4096
  ds_read_b64_tr_b16 v[62:63], v9 offset:4608
  s_waitcnt lgkmcnt(8)
  v_mfma_f32_16x16x32_bf16 v[68:71], v[48:51], v[20:23], v[68:71]
  s_waitcnt lgkmcnt(7)
  v_mfma_f32_16x16x32_bf16 v[72:75], v[48:51], v[24:27], v[72:75]
  s_waitcnt lgkmcnt(6)
  v_mfma_f32_16x16x32_bf16 v[76:79], v[48:51], v[28:31], v[76:79]
  s_waitcnt lgkmcnt(4)
  v_mfma_f32_16x16x32_bf16 v[80:83], v[52:55], v[16:19], v[80:83]
  ds_read_b64_tr_b16 v[48:49], v8 offset:8192
  ds_read_b64_tr_b16 v[50:51], v8 offset:8704
  v_mfma_f32_16x16x32_bf16 v[84:87], v[52:55], v[20:23], v[84:87]
  v_mfma_f32_16x16x32_bf16 v[88:91], v[52:55], v[24:27], v[88:91]
  v_mfma_f32_16x16x32_bf16 v[92:95], v[52:55], v[28:31], v[92:95]
  s_waitcnt lgkmcnt(4)
  v_mfma_f32_16x16x32_bf16 v[96:99], v[56:59], v[16:19], v[96:99]
  ds_read_b64_tr_b16 v[52:53], v9 offset:8192
  ds_read_b64_tr_b16 v[54:55], v9 offset:8704
  v_mfma_f32_16x16x32_bf16 v[100:103], v[56:59], v[20:23], v[100:103]
  v_mfma_f32_16x16x32_bf16 v[104:107], v[56:59], v[24:27], v[104:107]
  v_mfma_f32_16x16x32_bf16 v[108:111], v[56:59], v[28:31], v[108:111]
  s_waitcnt lgkmcnt(4)
  v_mfma_f32_16x16x32_bf16 v[112:115], v[60:63], v[16:19], v[112:115]
  ds_read_b64_tr_b16 v[56:57], v8 offset:12288
  ds_read_b64_tr_b16 v[58:59], v8 offset:12800
  v_mfma_f32_16x16x32_bf16 v[116:119], v[60:63], v[20:23], v[116:119]
  ds_read_b128 v[32:35], v7 offset:0
  ds_read_b128 v[36:39], v7 offset:2048
  v_mfma_f32_16x16x32_bf16 v[120:123], v[60:63], v[24:27], v[120:123]
  ds_read_b128 v[40:43], v7 offset:4096
  ds_read_b128 v[44:47], v7 offset:6144
  v_add_u32 v7, s62, v7
  v_mfma_f32_16x16x32_bf16 v[124:127], v[60:63], v[28:31], v[124:127]
  s_waitcnt lgkmcnt(8)
  v_mfma_f32_16x16x32_bf16 v[128:131], v[16:19], v[48:51], v[128:131]
  ds_read_b64_tr_b16 v[60:61], v9 offset:12288
  ds_read_b64_tr_b16 v[62:63], v9 offset:12800
  v_mfma_f32_16x16x32_bf16 v[132:135], v[20:23], v[48:51], v[132:135]
  v_mfma_f32_16x16x32_bf16 v[136:139], v[24:27], v[48:51], v[136:139]
  v_mfma_f32_16x16x32_bf16 v[140:143], v[28:31], v[48:51], v[140:143]
  s_waitcnt lgkmcnt(8)
  v_mfma_f32_16x16x32_bf16 v[144:147], v[16:19], v[52:55], v[144:147]
  ds_read_b64_tr_b16 v[48:49], v8 offset:16384
  ds_read_b64_tr_b16 v[50:51], v8 offset:16896
  v_mfma_f32_16x16x32_bf16 v[148:151], v[20:23], v[52:55], v[148:151]
  v_mfma_f32_16x16x32_bf16 v[152:155], v[24:27], v[52:55], v[152:155]
  v_mfma_f32_16x16x32_bf16 v[156:159], v[28:31], v[52:55], v[156:159]
  s_waitcnt lgkmcnt(8)
  s_waitcnt lgkmcnt(7)
  v_mfma_f32_16x16x32_bf16 v[64:67], v[56:59], v[32:35], v[64:67]
  ds_read_b64_tr_b16 v[52:53], v9 offset:16384
  ds_read_b64_tr_b16 v[54:55], v9 offset:16896
  s_waitcnt lgkmcnt(8)
  v_mfma_f32_16x16x32_bf16 v[68:71], v[56:59], v[36:39], v[68:71]
  s_waitcnt lgkmcnt(7)
  v_mfma_f32_16x16x32_bf16 v[72:75], v[56:59], v[40:43], v[72:75]
  s_waitcnt lgkmcnt(6)
  v_mfma_f32_16x16x32_bf16 v[76:79], v[56:59], v[44:47], v[76:79]
  s_waitcnt lgkmcnt(4)
  v_mfma_f32_16x16x32_bf16 v[80:83], v[60:63], v[32:35], v[80:83]
  ds_read_b64_tr_b16 v[56:57], v8 offset:20480
  ds_read_b64_tr_b16 v[58:59], v8 offset:20992
  v_mfma_f32_16x16x32_bf16 v[84:87], v[60:63], v[36:39], v[84:87]
  v_mfma_f32_16x16x32_bf16 v[88:91], v[60:63], v[40:43], v[88:91]
  v_mfma_f32_16x16x32_bf16 v[92:95], v[60:63], v[44:47], v[92:95]
  s_waitcnt lgkmcnt(4)
  v_mfma_f32_16x16x32_bf16 v[96:99], v[48:51], v[32:35], v[96:99]
  ds_read_b64_tr_b16 v[60:61], v9 offset:20480
  ds_read_b64_tr_b16 v[62:63], v9 offset:20992
  v_mfma_f32_16x16x32_bf16 v[100:103], v[48:51], v[36:39], v[100:103]
  v_mfma_f32_16x16x32_bf16 v[104:107], v[48:51], v[40:43], v[104:107]
  v_mfma_f32_16x16x32_bf16 v[108:111], v[48:51], v[44:47], v[108:111]
  v_xor_b32 v8, 0x6000, v8
  v_xor_b32 v9, 0x6000, v9
  v_add_u32 v6, s62, v6
  s_waitcnt lgkmcnt(0)
  s_barrier
  v_mfma_f32_16x16x32_bf16 v[112:115], v[52:55], v[32:35], v[112:115]
  ds_read_b64_tr_b16 v[48:49], v8 offset:0
  ds_read_b64_tr_b16 v[50:51], v8 offset:512
  v_mfma_f32_16x16x32_bf16 v[116:119], v[52:55], v[36:39], v[116:119]
  ds_read_b128 v[16:19], v6 offset:0
  ds_read_b128 v[20:23], v6 offset:2048
  v_mfma_f32_16x16x32_bf16 v[120:123], v[52:55], v[40:43], v[120:123]
  ds_read_b128 v[24:27], v6 offset:4096
  ds_read_b128 v[28:31], v6 offset:6144
  v_mfma_f32_16x16x32_bf16 v[124:127], v[52:55], v[44:47], v[124:127]
  v_mfma_f32_16x16x32_bf16 v[128:131], v[32:35], v[56:59], v[128:131]
  ds_read_b64_tr_b16 v[52:53], v9 offset:0
  ds_read_b64_tr_b16 v[54:55], v9 offset:512
  v_mfma_f32_16x16x32_bf16 v[132:135], v[36:39], v[56:59], v[132:135]
  v_mfma_f32_16x16x32_bf16 v[136:139], v[40:43], v[56:59], v[136:139]
  v_mfma_f32_16x16x32_bf16 v[140:143], v[44:47], v[56:59], v[140:143]
  v_mfma_f32_16x16x32_bf16 v[144:147], v[32:35], v[60:63], v[144:147]
  ds_read_b64_tr_b16 v[56:57], v8 offset:4096
  ds_read_b64_tr_b16 v[58:59], v8 offset:4608
  v_mfma_f32_16x16x32_bf16 v[148:151], v[36:39], v[60:63], v[148:151]
  v_mfma_f32_16x16x32_bf16 v[152:155], v[40:43], v[60:63], v[152:155]
  v_mfma_f32_16x16x32_bf16 v[156:159], v[44:47], v[60:63], v[156:159]
  s_mov_b32 s59, s67
  s_add_u32 s58, s58, 1
  s_cmp_lt_u32 s58, 16
  s_cbranch_scc1 P1_LOOP
  s_waitcnt lgkmcnt(0)

  s_lshl_b32 s64, s49, 3
  s_lshl_b32 s65, s51, 1
  s_add_u32 s64, s64, s65
  s_lshl_b32 s65, s53, 6
  s_add_u32 s64, s64, s65
  s_lshl_b32 s65, s64, 11
  s_cmp_eq_u32 s48, 0
  s_cbranch_scc0 P1_EPI_B
  s_lshl_b32 s66, s64, 12
  s_add_u32 s66, s66, 4194304
  s_add_u32 s67, s66, 4096
  s_add_u32 s65, s65, 0

  v_lshrrev_b32 v12, 5, v1
  v_lshlrev_b32 v12, 10, v12
  v_bfe_u32 v13, v1, 4, 1
  v_lshl_add_u32 v12, v13, 9, v12
  v_and_b32 v13, 15, v1
  v_lshl_add_u32 v10, v13, 4, v12
  v_and_b32 v13, 7, v1
  v_lshl_add_u32 v11, v13, 4, v12
  v_bfe_u32 v13, v1, 3, 1
  v_lshl_add_u32 v11, v13, 8, v11

  v_cvt_pk_bf16_f32 v16, v96, v97
  v_cvt_pk_bf16_f32 v17, v98, v99
  v_cvt_pk_bf16_f32 v18, v112, v113
  v_cvt_pk_bf16_f32 v19, v114, v115
  buffer_store_dwordx4 v[16:19], v11, s[32:35], s66 offen offset:0 sc1
  v_cvt_pk_bf16_f32 v20, v100, v101
  v_cvt_pk_bf16_f32 v21, v102, v103
  v_cvt_pk_bf16_f32 v22, v116, v117
  v_cvt_pk_bf16_f32 v23, v118, v119
  buffer_store_dwordx4 v[20:23], v11, s[32:35], s66 offen offset:128 sc1
  v_cvt_pk_bf16_f32 v24, v104, v105
  v_cvt_pk_bf16_f32 v25, v106, v107
  v_cvt_pk_bf16_f32 v26, v120, v121
  v_cvt_pk_bf16_f32 v27, v122, v123
  buffer_store_dwordx4 v[24:27], v11, s[32:35], s67 offen offset:0 sc1
  v_cvt_pk_bf16_f32 v28, v108, v109
  v_cvt_pk_bf16_f32 v29, v110, v111
  v_cvt_pk_bf16_f32 v30, v124, v125
  v_cvt_pk_bf16_f32 v31, v126, v127
  buffer_store_dwordx4 v[28:31], v11, s[32:35], s67 offen offset:128 sc1
  v_cvt_pk_bf16_f32 v32, v128, v129
  v_cvt_pk_bf16_f32 v33, v130, v131
  v_cvt_pk_bf16_f32 v34, v132, v133
  v_cvt_pk_bf16_f32 v35, v134, v135
  buffer_store_dwordx4 v[32:35], v10, s[32:35], s66 offen offset:2048 sc1
  v_cvt_pk_bf16_f32 v36, v144, v145
  v_cvt_pk_bf16_f32 v37, v146, v147
  v_cvt_pk_bf16_f32 v38, v148, v149
  v_cvt_pk_bf16_f32 v39, v150, v151
  buffer_store_dwordx4 v[36:39], v10, s[32:35], s66 offen offset:2304 sc1
  v_cvt_pk_bf16_f32 v40, v136, v137
  v_cvt_pk_bf16_f32 v41, v138, v139
  v_cvt_pk_bf16_f32 v42, v140, v141
  v_cvt_pk_bf16_f32 v43, v142, v143
  buffer_store_dwordx4 v[40:43], v10, s[32:35], s67 offen offset:2048 sc1
  v_cvt_pk_bf16_f32 v44, v152, v153
  v_cvt_pk_bf16_f32 v45, v154, v155
  v_cvt_pk_bf16_f32 v46, v156, v157
  v_cvt_pk_bf16_f32 v47, v158, v159
  buffer_store_dwordx4 v[44:47], v10, s[32:35], s67 offen offset:2304 sc1
  v_mul_f32 v64, s63, v64
  v_mul_f32 v65, s63, v65
  v_mul_f32 v66, s63, v66
  v_mul_f32 v67, s63, v67
  v_mul_f32 v80, s63, v80
  v_mul_f32 v81, s63, v81
  v_mul_f32 v82, s63, v82
  v_mul_f32 v83, s63, v83
  v_cvt_pk_bf16_f32 v48, v64, v65
  v_cvt_pk_bf16_f32 v49, v66, v67
  v_cvt_pk_bf16_f32 v50, v80, v81
  v_cvt_pk_bf16_f32 v51, v82, v83
  v_mul_f32 v68, s63, v68
  v_mul_f32 v69, s63, v69
  v_mul_f32 v70, s63, v70
  v_mul_f32 v71, s63, v71
  v_mul_f32 v84, s63, v84
  v_mul_f32 v85, s63, v85
  v_mul_f32 v86, s63, v86
  v_mul_f32 v87, s63, v87
  v_cvt_pk_bf16_f32 v52, v68, v69
  v_cvt_pk_bf16_f32 v53, v70, v71
  v_cvt_pk_bf16_f32 v54, v84, v85
  v_cvt_pk_bf16_f32 v55, v86, v87
  v_mul_f32 v72, s63, v72
  v_mul_f32 v73, s63, v73
  v_mul_f32 v74, s63, v74
  v_mul_f32 v75, s63, v75
  v_mul_f32 v88, s63, v88
  v_mul_f32 v89, s63, v89
  v_mul_f32 v90, s63, v90
  v_mul_f32 v91, s63, v91
  v_cvt_pk_bf16_f32 v56, v72, v73
  v_cvt_pk_bf16_f32 v57, v74, v75
  v_cvt_pk_bf16_f32 v58, v88, v89
  v_cvt_pk_bf16_f32 v59, v90, v91
  v_mul_f32 v76, s63, v76
  v_mul_f32 v77, s63, v77
  v_mul_f32 v78, s63, v78
  v_mul_f32 v79, s63, v79
  v_mul_f32 v92, s63, v92
  v_mul_f32 v93, s63, v93
  v_mul_f32 v94, s63, v94
  v_mul_f32 v95, s63, v95
  v_cvt_pk_bf16_f32 v60, v76, v77
  v_cvt_pk_bf16_f32 v61, v78, v79
  v_cvt_pk_bf16_f32 v62, v92, v93
  v_cvt_pk_bf16_f32 v63, v94, v95
  s_cmp_eq_u32 s52, 0
  s_cbranch_scc1 P1_NOQA
  buffer_store_dwordx4 v[48:51], v10, s[32:35], s65 offen offset:0 sc1
  buffer_store_dwordx4 v[52:55], v10, s[32:35], s65 offen offset:256 sc1
  buffer_store_dwordx4 v[56:59], v10, s[32:35], s65 offen offset:2048 sc1
  buffer_store_dwordx4 v[60:63], v10, s[32:35], s65 offen offset:2304 sc1
P1_NOQA:
  s_lshl_b32 s64, s50, 3
  s_add_u32 s64, s64, s49
  s_lshl_b32 s64, s64, 7
  s_add_u32 s64, s64, 37748736
  s_lshl_b32 s66, s51, 13
  v_add_u32 v11, s66, v11
  v_add_u32 v12, s66, v10
  s_lshl_b32 s66, s51, 12
  s_add_u32 s66, s66, 139264
  v_add_u32 v10, s66, v10
  s_barrier
  s_barrier
  s_cmp_lg_u32 s52, 0
  s_cbranch_scc1 P1_NOLW

  ds_write_b128 v11, v[16:19] offset:0
  ds_write_b128 v11, v[20:23] offset:128
  ds_write_b128 v11, v[24:27] offset:4096
  ds_write_b128 v11, v[28:31] offset:4224
  ds_write_b128 v12, v[32:35] offset:2048
  ds_write_b128 v12, v[36:39] offset:2304
  ds_write_b128 v12, v[40:43] offset:6144
  ds_write_b128 v12, v[44:47] offset:6400
  ds_write_b128 v10, v[48:51] offset:0
  ds_write_b128 v10, v[52:55] offset:256
  ds_write_b128 v10, v[56:59] offset:2048
  ds_write_b128 v10, v[60:63] offset:2304
  s_waitcnt lgkmcnt(0)
  s_mov_b64 exec, 1
  ds_add_u32 v3, v4 offset:4
  s_mov_b64 exec, -1
P1_NOLW:
  s_waitcnt vmcnt(0)
  v_mov_b32 v160, 163776
  v_mov_b32 v161, 1
  s_mov_b64 exec, 1
  ds_add_rtn_u32 v164, v160, v161 offset:16
  ds_read_b64 v[162:163], v160 offset:32
  v_mov_b32 v160, 0
  s_waitcnt lgkmcnt(0)
  v_readfirstlane_b32 s65, v164
  s_nop 0
  s_cmp_lg_u32 s65, 7
  s_cbranch_scc1 LW22
  buffer_store_dwordx2 v[162:163], v160, s[32:35], s64 offen sc0 sc1

LW22:
  s_mov_b64 exec, -1
  s_branch P1_FIN
P1_EPI_B:
  s_add_u32 s65, s65, 12582912
  v_cvt_pk_bf16_f32 v48, v128, v129
  v_cvt_pk_bf16_f32 v49, v130, v131
  v_cvt_pk_bf16_f32 v50, v132, v133
  v_cvt_pk_bf16_f32 v51, v134, v135
  v_cvt_pk_bf16_f32 v52, v144, v145
  v_cvt_pk_bf16_f32 v53, v146, v147
  v_cvt_pk_bf16_f32 v54, v148, v149
  v_cvt_pk_bf16_f32 v55, v150, v151
  v_cvt_pk_bf16_f32 v56, v136, v137
  v_cvt_pk_bf16_f32 v57, v138, v139
  v_cvt_pk_bf16_f32 v58, v140, v141
  v_cvt_pk_bf16_f32 v59, v142, v143
  v_cvt_pk_bf16_f32 v60, v152, v153
  v_cvt_pk_bf16_f32 v61, v154, v155
  v_cvt_pk_bf16_f32 v62, v156, v157
  v_cvt_pk_bf16_f32 v63, v158, v159
  v_cvt_pk_bf16_f32 v136, v64, v65
  v_cvt_pk_bf16_f32 v137, v66, v67
  v_cvt_pk_bf16_f32 v138, v80, v81
  v_cvt_pk_bf16_f32 v139, v82, v83
  v_cvt_pk_bf16_f32 v140, v68, v69
  v_cvt_pk_bf16_f32 v141, v70, v71
  v_cvt_pk_bf16_f32 v142, v84, v85
  v_cvt_pk_bf16_f32 v143, v86, v87
  v_cvt_pk_bf16_f32 v144, v72, v73
  v_cvt_pk_bf16_f32 v145, v74, v75
  v_cvt_pk_bf16_f32 v146, v88, v89
  v_cvt_pk_bf16_f32 v147, v90, v91
  v_cvt_pk_bf16_f32 v148, v76, v77
  v_cvt_pk_bf16_f32 v149, v78, v79
  v_cvt_pk_bf16_f32 v150, v92, v93
  v_cvt_pk_bf16_f32 v151, v94, v95
  buffer_store_dwordx4 v[136:139], v2, s[32:35], s65 offen offset:0 sc1
  buffer_store_dwordx4 v[140:143], v2, s[32:35], s65 offen offset:1024 sc1
  buffer_store_dwordx4 v[144:147], v2, s[32:35], s65 offen offset:2048 sc1
  buffer_store_dwordx4 v[148:151], v2, s[32:35], s65 offen offset:3072 sc1
  v_cvt_pk_bf16_f32 v32, v96, v97
  v_cvt_pk_bf16_f32 v33, v98, v99
  v_cvt_pk_bf16_f32 v34, v112, v113
  v_cvt_pk_bf16_f32 v35, v114, v115
  v_cvt_pk_bf16_f32 v36, v100, v101
  v_cvt_pk_bf16_f32 v37, v102, v103
  v_cvt_pk_bf16_f32 v38, v116, v117
  v_cvt_pk_bf16_f32 v39, v118, v119
  v_cvt_pk_bf16_f32 v40, v104, v105
  v_cvt_pk_bf16_f32 v41, v106, v107
  v_cvt_pk_bf16_f32 v42, v120, v121
  v_cvt_pk_bf16_f32 v43, v122, v123
  v_cvt_pk_bf16_f32 v44, v108, v109
  v_cvt_pk_bf16_f32 v45, v110, v111
  v_cvt_pk_bf16_f32 v46, v124, v125
  v_cvt_pk_bf16_f32 v47, v126, v127
  v_lshrrev_b32 v12, 2, v1
  v_and_b32 v13, 3, v1
  v_lshlrev_b32 v13, 3, v13
  v_lshl_add_u32 v6, v12, 6, v13
  s_lshl_b32 s64, s52, 11
  s_add_u32 s64, s64, 155648
  v_add_u32 v6, s64, v6

  ds_read_b64_tr_b16 v[160:161], v6 offset:0
  ds_read_b64_tr_b16 v[162:163], v6 offset:1024
  ds_read_b64_tr_b16 v[164:165], v6 offset:32
  ds_read_b64_tr_b16 v[166:167], v6 offset:1056
  v_and_b32 v12, 15, v1
  v_mul_u32_u24 v12, 72, v12
  v_lshrrev_b32 v13, 4, v1
  v_lshl_add_u32 v12, v13, 3, v12
  s_mul_i32 s64, s24, 9216
  s_add_u32 s64, s64, 32768
  v_add_u32 v7, s64, v12
  s_lshl_b32 s64, s24, 12
  s_add_u32 s64, s64, 106496
  v_add_u32 v9, s64, v2
  s_lshl_b32 s64, s50, 3
  s_add_u32 s64, s64, s49
  s_lshl_b32 s64, s64, 7
  s_add_u32 s64, s64, 37765120
  s_waitcnt lgkmcnt(0)

  v_mfma_f32_16x16x32_bf16 v[64:67], v[160:163], v[32:35], 0
  v_mfma_f32_16x16x32_bf16 v[68:71], v[164:167], v[32:35], 0
  v_mfma_f32_16x16x32_bf16 v[72:75], v[160:163], v[36:39], 0
  v_mfma_f32_16x16x32_bf16 v[76:79], v[164:167], v[36:39], 0
  v_mfma_f32_16x16x32_bf16 v[80:83], v[160:163], v[40:43], 0
  v_mfma_f32_16x16x32_bf16 v[84:87], v[164:167], v[40:43], 0
  v_mfma_f32_16x16x32_bf16 v[88:91], v[160:163], v[44:47], 0
  v_mfma_f32_16x16x32_bf16 v[92:95], v[164:167], v[44:47], 0
  s_barrier
  ds_write_b128 v9, v[48:51] offset:0
  ds_write_b128 v9, v[52:55] offset:1024
  ds_write_b128 v9, v[56:59] offset:2048
  ds_write_b128 v9, v[60:63] offset:3072
  s_waitcnt lgkmcnt(0)
  s_barrier
  s_nop 1
  v_max3_f32 v152, v64, v65, v66
  v_max3_f32 v156, -v64, -v65, -v66
  v_max3_f32 v153, v72, v73, v74
  v_max3_f32 v157, -v72, -v73, -v74
  v_max3_f32 v154, v80, v81, v82
  v_max3_f32 v158, -v80, -v81, -v82
  v_max3_f32 v155, v88, v89, v90
  v_max3_f32 v159, -v88, -v89, -v90
  v_max3_f32 v152, v152, v67, v68
  v_max3_f32 v156, v156, -v67, -v68
  v_max3_f32 v153, v153, v75, v76
  v_max3_f32 v157, v157, -v75, -v76
  v_max3_f32 v154, v154, v83, v84
  v_max3_f32 v158, v158, -v83, -v84
  v_max3_f32 v155, v155, v91, v92
  v_max3_f32 v159, v159, -v91, -v92
  v_max3_f32 v152, v152, v69, v70
  v_max3_f32 v156, v156, -v69, -v70
  v_max3_f32 v153, v153, v77, v78
  v_max3_f32 v157, v157, -v77, -v78
  v_max3_f32 v154, v154, v85, v86
  v_max3_f32 v158, v158, -v85, -v86
  v_max3_f32 v155, v155, v93, v94
  v_max3_f32 v159, v159, -v93, -v94
  v_max_f32 v152, v152, v71
  v_max_f32 v156, v156, -v71
  v_max_f32 v153, v153, v79
  v_max_f32 v157, v157, -v79
  v_max_f32 v154, v154, v87
  v_max_f32 v158, v158, -v87
  v_max_f32 v155, v155, v95
  v_max_f32 v159, v159, -v95
  s_nop 1
  v_permlane32_swap_b32 v152, v156
  v_permlane32_swap_b32 v153, v157
  v_permlane32_swap_b32 v154, v158
  v_permlane32_swap_b32 v155, v159
  v_max_f32 v152, v152, v156
  v_max_f32 v153, v153, v157
  v_max_f32 v154, v154, v158
  v_max_f32 v155, v155, v159
  s_nop 1
  v_permlane16_swap_b32 v152, v153
  v_permlane16_swap_b32 v154, v155
  s_nop 0
  v_max_f32 v152, v152, v153
  v_max_f32 v154, v154, v155
  v_mul_f32 v152, s28, v152
  v_mul_f32 v154, s28, v154
  s_nop 0
  v_mov_b32 v153, v152
  v_mov_b32 v155, v154
  s_nop 1
  v_permlane16_swap_b32 v152, v153
  v_permlane16_swap_b32 v154, v155
  s_nop 0
  v_mov_b32 v156, v152
  v_mov_b32 v157, v153
  v_mov_b32 v158, v154
  v_mov_b32 v159, v155
  s_nop 1
  v_permlane32_swap_b32 v152, v156
  v_permlane32_swap_b32 v153, v157
  v_permlane32_swap_b32 v154, v158
  v_permlane32_swap_b32 v155, v159
  s_nop 0
  v_fma_f32 v96, -v64, s28, -v156
  v_fma_f32 v64, v64, s28, -v152
  v_fma_f32 v97, -v65, s28, -v156
  v_fma_f32 v65, v65, s28, -v152
  v_fma_f32 v98, -v66, s28, -v156
  v_fma_f32 v66, v66, s28, -v152
  v_fma_f32 v99, -v67, s28, -v156
  v_fma_f32 v67, v67, s28, -v152
  v_fma_f32 v100, -v68, s28, -v156
  v_fma_f32 v68, v68, s28, -v152
  v_fma_f32 v101, -v69, s28, -v156
  v_fma_f32 v69, v69, s28, -v152
  v_fma_f32 v102, -v70, s28, -v156
  v_fma_f32 v70, v70, s28, -v152
  v_fma_f32 v103, -v71, s28, -v156
  v_fma_f32 v71, v71, s28, -v152
  v_fma_f32 v104, -v72, s28, -v157
  v_fma_f32 v72, v72, s28, -v153
  v_fma_f32 v105, -v73, s28, -v157
  v_fma_f32 v73, v73, s28, -v153
  v_fma_f32 v106, -v74, s28, -v157
  v_fma_f32 v74, v74, s28, -v153
  v_fma_f32 v107, -v75, s28, -v157
  v_fma_f32 v75, v75, s28, -v153
  v_fma_f32 v108, -v76, s28, -v157
  v_fma_f32 v76, v76, s28, -v153
  v_fma_f32 v109, -v77, s28, -v157
  v_fma_f32 v77, v77, s28, -v153
  v_fma_f32 v110, -v78, s28, -v157
  v_fma_f32 v78, v78, s28, -v153
  v_fma_f32 v111, -v79, s28, -v157
  v_fma_f32 v79, v79, s28, -v153
  v_fma_f32 v112, -v80, s28, -v158
  v_fma_f32 v80, v80, s28, -v154
  v_fma_f32 v113, -v81, s28, -v158
  v_fma_f32 v81, v81, s28, -v154
  v_fma_f32 v114, -v82, s28, -v158
  v_fma_f32 v82, v82, s28, -v154
  v_fma_f32 v115, -v83, s28, -v158
  v_fma_f32 v83, v83, s28, -v154
  v_fma_f32 v116, -v84, s28, -v158
  v_fma_f32 v84, v84, s28, -v154
  v_fma_f32 v117, -v85, s28, -v158
  v_fma_f32 v85, v85, s28, -v154
  v_fma_f32 v118, -v86, s28, -v158
  v_fma_f32 v86, v86, s28, -v154
  v_fma_f32 v119, -v87, s28, -v158
  v_fma_f32 v87, v87, s28, -v154
  v_fma_f32 v120, -v88, s28, -v159
  v_fma_f32 v88, v88, s28, -v155
  v_fma_f32 v121, -v89, s28, -v159
  v_fma_f32 v89, v89, s28, -v155
  v_fma_f32 v122, -v90, s28, -v159
  v_fma_f32 v90, v90, s28, -v155
  v_fma_f32 v123, -v91, s28, -v159
  v_fma_f32 v91, v91, s28, -v155
  v_fma_f32 v124, -v92, s28, -v159
  v_fma_f32 v92, v92, s28, -v155
  v_fma_f32 v125, -v93, s28, -v159
  v_fma_f32 v93, v93, s28, -v155
  v_fma_f32 v126, -v94, s28, -v159
  v_fma_f32 v94, v94, s28, -v155
  v_fma_f32 v127, -v95, s28, -v159
  v_fma_f32 v95, v95, s28, -v155
  v_exp_f32 v96, v96
  v_exp_f32 v64, v64
  v_exp_f32 v97, v97
  v_exp_f32 v65, v65
  v_exp_f32 v98, v98
  v_exp_f32 v66, v66
  v_exp_f32 v99, v99
  v_exp_f32 v67, v67
  v_exp_f32 v100, v100
  v_exp_f32 v68, v68
  v_exp_f32 v101, v101
  v_exp_f32 v69, v69
  v_exp_f32 v102, v102
  v_exp_f32 v70, v70
  v_exp_f32 v103, v103
  v_exp_f32 v71, v71
  v_exp_f32 v104, v104
  v_exp_f32 v72, v72
  v_exp_f32 v105, v105
  v_exp_f32 v73, v73
  v_exp_f32 v106, v106
  v_exp_f32 v74, v74
  v_exp_f32 v107, v107
  v_exp_f32 v75, v75
  v_exp_f32 v108, v108
  v_exp_f32 v76, v76
  v_exp_f32 v109, v109
  v_exp_f32 v77, v77
  v_exp_f32 v110, v110
  v_exp_f32 v78, v78
  v_exp_f32 v111, v111
  v_exp_f32 v79, v79
  v_exp_f32 v112, v112
  v_exp_f32 v80, v80
  v_exp_f32 v113, v113
  v_exp_f32 v81, v81
  v_exp_f32 v114, v114
  v_exp_f32 v82, v82
  v_exp_f32 v115, v115
  v_exp_f32 v83, v83
  v_exp_f32 v116, v116
  v_exp_f32 v84, v84
  v_exp_f32 v117, v117
  v_exp_f32 v85, v85
  v_exp_f32 v118, v118
  v_exp_f32 v86, v86
  v_exp_f32 v119, v119
  v_exp_f32 v87, v87
  v_exp_f32 v120, v120
  v_exp_f32 v88, v88
  v_exp_f32 v121, v121
  v_exp_f32 v89, v89
  v_exp_f32 v122, v122
  v_exp_f32 v90, v90
  v_exp_f32 v123, v123
  v_exp_f32 v91, v91
  v_exp_f32 v124, v124
  v_exp_f32 v92, v92
  v_exp_f32 v125, v125
  v_exp_f32 v93, v93
  v_exp_f32 v126, v126
  v_exp_f32 v94, v94
  v_exp_f32 v127, v127
  v_exp_f32 v95, v95
  s_nop 0
  v_add_f32 v152, v64, v65
  v_add_f32 v156, v96, v97
  v_add_f32 v153, v72, v73
  v_add_f32 v157, v104, v105
  v_add_f32 v154, v80, v81
  v_add_f32 v158, v112, v113
  v_add_f32 v155, v88, v89
  v_add_f32 v159, v120, v121
  v_add_f32 v152, v152, v66
  v_add_f32 v156, v156, v98
  v_add_f32 v153, v153, v74
  v_add_f32 v157, v157, v106
  v_add_f32 v154, v154, v82
  v_add_f32 v158, v158, v114
  v_add_f32 v155, v155, v90
  v_add_f32 v159, v159, v122
  v_add_f32 v152, v152, v67
  v_add_f32 v156, v156, v99
  v_add_f32 v153, v153, v75
  v_add_f32 v157, v157, v107
  v_add_f32 v154, v154, v83
  v_add_f32 v158, v158, v115
  v_add_f32 v155, v155, v91
  v_add_f32 v159, v159, v123
  v_add_f32 v152, v152, v68
  v_add_f32 v156, v156, v100
  v_add_f32 v153, v153, v76
  v_add_f32 v157, v157, v108
  v_add_f32 v154, v154, v84
  v_add_f32 v158, v158, v116
  v_add_f32 v155, v155, v92
  v_add_f32 v159, v159, v124
  v_add_f32 v152, v152, v69
  v_add_f32 v156, v156, v101
  v_add_f32 v153, v153, v77
  v_add_f32 v157, v157, v109
  v_add_f32 v154, v154, v85
  v_add_f32 v158, v158, v117
  v_add_f32 v155, v155, v93
  v_add_f32 v159, v159, v125
  v_add_f32 v152, v152, v70
  v_add_f32 v156, v156, v102
  v_add_f32 v153, v153, v78
  v_add_f32 v157, v157, v110
  v_add_f32 v154, v154, v86
  v_add_f32 v158, v158, v118
  v_add_f32 v155, v155, v94
  v_add_f32 v159, v159, v126
  v_add_f32 v152, v152, v71
  v_add_f32 v156, v156, v103
  v_add_f32 v153, v153, v79
  v_add_f32 v157, v157, v111
  v_add_f32 v154, v154, v87
  v_add_f32 v158, v158, v119
  v_add_f32 v155, v155, v95
  v_add_f32 v159, v159, v127
  s_nop 1
  v_permlane32_swap_b32 v152, v156
  v_permlane32_swap_b32 v153, v157
  v_permlane32_swap_b32 v154, v158
  v_permlane32_swap_b32 v155, v159
  v_add_f32 v152, v152, v156
  v_add_f32 v153, v153, v157
  v_add_f32 v154, v154, v158
  v_add_f32 v155, v155, v159
  s_nop 1
  v_permlane16_swap_b32 v152, v153
  v_permlane16_swap_b32 v154, v155
  s_nop 0
  v_add_f32 v152, v152, v153
  v_add_f32 v154, v154, v155
  v_rcp_f32 v152, v152
  v_rcp_f32 v154, v154
  s_nop 0
  v_mov_b32 v153, v152
  v_mov_b32 v155, v154
  s_nop 1
  v_permlane16_swap_b32 v152, v153
  v_permlane16_swap_b32 v154, v155
  s_nop 0
  v_mov_b32 v156, v152
  v_mov_b32 v157, v153
  v_mov_b32 v158, v154
  v_mov_b32 v159, v155
  s_nop 1
  v_permlane32_swap_b32 v152, v156
  v_permlane32_swap_b32 v153, v157
  v_permlane32_swap_b32 v154, v158
  v_permlane32_swap_b32 v155, v159
  s_nop 0
  v_mul_f32 v64, v152, v64
  v_mul_f32 v96, v156, v96
  v_mul_f32 v65, v152, v65
  v_mul_f32 v97, v156, v97
  v_mul_f32 v66, v152, v66
  v_mul_f32 v98, v156, v98
  v_mul_f32 v67, v152, v67
  v_mul_f32 v99, v156, v99
  v_mul_f32 v68, v152, v68
  v_mul_f32 v100, v156, v100
  v_mul_f32 v69, v152, v69
  v_mul_f32 v101, v156, v101
  v_mul_f32 v70, v152, v70
  v_mul_f32 v102, v156, v102
  v_mul_f32 v71, v152, v71
  v_mul_f32 v103, v156, v103
  v_mul_f32 v72, v153, v72
  v_mul_f32 v104, v157, v104
  v_mul_f32 v73, v153, v73
  v_mul_f32 v105, v157, v105
  v_mul_f32 v74, v153, v74
  v_mul_f32 v106, v157, v106
  v_mul_f32 v75, v153, v75
  v_mul_f32 v107, v157, v107
  v_mul_f32 v76, v153, v76
  v_mul_f32 v108, v157, v108
  v_mul_f32 v77, v153, v77
  v_mul_f32 v109, v157, v109
  v_mul_f32 v78, v153, v78
  v_mul_f32 v110, v157, v110
  v_mul_f32 v79, v153, v79
  v_mul_f32 v111, v157, v111
  v_mul_f32 v80, v154, v80
  v_mul_f32 v112, v158, v112
  v_mul_f32 v81, v154, v81
  v_mul_f32 v113, v158, v113
  v_mul_f32 v82, v154, v82
  v_mul_f32 v114, v158, v114
  v_mul_f32 v83, v154, v83
  v_mul_f32 v115, v158, v115
  v_mul_f32 v84, v154, v84
  v_mul_f32 v116, v158, v116
  v_mul_f32 v85, v154, v85
  v_mul_f32 v117, v158, v117
  v_mul_f32 v86, v154, v86
  v_mul_f32 v118, v158, v118
  v_mul_f32 v87, v154, v87
  v_mul_f32 v119, v158, v119
  v_mul_f32 v88, v155, v88
  v_mul_f32 v120, v159, v120
  v_mul_f32 v89, v155, v89
  v_mul_f32 v121, v159, v121
  v_mul_f32 v90, v155, v90
  v_mul_f32 v122, v159, v122
  v_mul_f32 v91, v155, v91
  v_mul_f32 v123, v159, v123
  v_mul_f32 v92, v155, v92
  v_mul_f32 v124, v159, v124
  v_mul_f32 v93, v155, v93
  v_mul_f32 v125, v159, v125
  v_mul_f32 v94, v155, v94
  v_mul_f32 v126, v159, v126
  v_mul_f32 v95, v155, v95
  v_mul_f32 v127, v159, v127
  v_cvt_pk_bf16_f32 v16, v64, v65
  v_cvt_pk_bf16_f32 v20, v96, v97
  v_cvt_pk_bf16_f32 v17, v66, v67
  v_cvt_pk_bf16_f32 v21, v98, v99
  v_cvt_pk_bf16_f32 v18, v68, v69
  v_cvt_pk_bf16_f32 v22, v100, v101
  v_cvt_pk_bf16_f32 v19, v70, v71
  v_cvt_pk_bf16_f32 v23, v102, v103
  v_cvt_pk_bf16_f32 v24, v72, v73
  v_cvt_pk_bf16_f32 v28, v104, v105
  v_cvt_pk_bf16_f32 v25, v74, v75
  v_cvt_pk_bf16_f32 v29, v106, v107
  v_cvt_pk_bf16_f32 v26, v76, v77
  v_cvt_pk_bf16_f32 v30, v108, v109
  v_cvt_pk_bf16_f32 v27, v78, v79
  v_cvt_pk_bf16_f32 v31, v110, v111
  v_cvt_pk_bf16_f32 v32, v80, v81
  v_cvt_pk_bf16_f32 v36, v112, v113
  v_cvt_pk_bf16_f32 v33, v82, v83
  v_cvt_pk_bf16_f32 v37, v114, v115
  v_cvt_pk_bf16_f32 v34, v84, v85
  v_cvt_pk_bf16_f32 v38, v116, v117
  v_cvt_pk_bf16_f32 v35, v86, v87
  v_cvt_pk_bf16_f32 v39, v118, v119
  v_cvt_pk_bf16_f32 v40, v88, v89
  v_cvt_pk_bf16_f32 v44, v120, v121
  v_cvt_pk_bf16_f32 v41, v90, v91
  v_cvt_pk_bf16_f32 v45, v122, v123
  v_cvt_pk_bf16_f32 v42, v92, v93
  v_cvt_pk_bf16_f32 v46, v124, v125
  v_cvt_pk_bf16_f32 v43, v94, v95
  v_cvt_pk_bf16_f32 v47, v126, v127
  ds_write_b64 v7, v[16:17] offset:0
  ds_write_b64 v7, v[18:19] offset:32
  ds_write_b64 v7, v[20:21] offset:4608
  ds_write_b64 v7, v[22:23] offset:4640
  ds_write_b64 v7, v[24:25] offset:1152
  ds_write_b64 v7, v[26:27] offset:1184
  ds_write_b64 v7, v[28:29] offset:5760
  ds_write_b64 v7, v[30:31] offset:5792
  ds_write_b64 v7, v[32:33] offset:2304
  ds_write_b64 v7, v[34:35] offset:2336
  ds_write_b64 v7, v[36:37] offset:6912
  ds_write_b64 v7, v[38:39] offset:6944
  ds_write_b64 v7, v[40:41] offset:3456
  ds_write_b64 v7, v[42:43] offset:3488
  ds_write_b64 v7, v[44:45] offset:8064
  ds_write_b64 v7, v[46:47] offset:8096
  s_waitcnt vmcnt(0)
  v_mov_b32 v160, 163776
  v_mov_b32 v161, 1
  s_mov_b64 exec, 1
  ds_add_rtn_u32 v164, v160, v161 offset:16
  ds_read_b64 v[162:163], v160 offset:32
  v_mov_b32 v160, 0
  s_waitcnt lgkmcnt(0)
  v_readfirstlane_b32 s65, v164
  s_nop 0
  s_cmp_lg_u32 s65, 7
  s_cbranch_scc1 LW23
  buffer_store_dwordx2 v[162:163], v160, s[32:35], s64 offen sc0 sc1

LW23:
  s_mov_b64 exec, -1
  v_lshrrev_b32 v12, 2, v1
  v_mul_u32_u24 v12, 72, v12
  v_and_b32 v13, 3, v1
  v_lshl_add_u32 v12, v13, 3, v12
  s_mul_i32 s64, s52, 36864
  s_lshr_b32 s65, s51, 1
  s_mul_i32 s65, s65, 4608
  s_add_u32 s64, s64, s65
  s_and_b32 s65, s51, 1
  s_lshl_b32 s65, s65, 5
  s_add_u32 s64, s64, s65
  s_add_u32 s64, s64, 32768
  v_add_u32 v8, s64, v12
  s_lshl_b32 s64, s52, 14
  s_add_u32 s64, s64, 106496
  v_add_u32 v14, s64, v2
  s_lshl_b32 s64, s53, 3
  s_add_u32 s64, s64, s49
  s_mul_i32 s64, s64, 12288
  s_add_u32 s64, s64, 25165824
  s_lshl_b32 s54, s51, 11
  s_add_u32 s54, s54, s64
  s_lshl_b32 s55, s51, 10
  s_add_u32 s55, s55, s64
  s_add_u32 s55, s55, 8192
  s_waitcnt lgkmcnt(0)

  v_mov_b32 v48, 0x3f803f80
  v_mov_b32 v49, 0x3f803f80
  v_mov_b32 v50, 0x3f803f80
  v_mov_b32 v51, 0x3f803f80
  s_mov_b64 exec, 1
  ds_add_u32 v3, v4 offset:0
  s_mov_b64 exec, -1
  s_mov_b32 s65, 0
SP24:
  ds_read_b32 v5, v3 offset:0
  s_add_u32 s65, s65, 1
  s_waitcnt lgkmcnt(0)
  v_readfirstlane_b32 s64, v5
  s_cmp_gt_u32 s65, 2000000
  s_cbranch_scc1 SP24_X
  s_cmp_ge_u32 s64, 8
  s_cbranch_scc1 SP24_X

  s_branch SP24
SP24_X:
  ds_read_b64_tr_b16 v[16:17], v8 offset:0
  ds_read_b64_tr_b16 v[18:19], v8 offset:1152
  ds_read_b128 v[64:67], v14 offset:0
  ds_read_b128 v[68:71], v14 offset:1024
  ds_read_b64_tr_b16 v[20:21], v8 offset:2304
  ds_read_b64_tr_b16 v[22:23], v8 offset:3456
  ds_read_b128 v[72:75], v14 offset:2048
  ds_read_b128 v[76:79], v14 offset:3072
  ds_read_b64_tr_b16 v[24:25], v8 offset:9216
  ds_read_b64_tr_b16 v[26:27], v8 offset:10368
  ds_read_b128 v[80:83], v14 offset:4096
  ds_read_b128 v[84:87], v14 offset:5120
  s_waitcnt lgkmcnt(8)
  ds_read_b64_tr_b16 v[28:29], v8 offset:11520
  ds_read_b64_tr_b16 v[30:31], v8 offset:12672
  ds_read_b128 v[88:91], v14 offset:6144
  ds_read_b128 v[92:95], v14 offset:7168
  v_mfma_f32_16x16x32_bf16 v[52:55], v[16:19], v[64:67], 0
  v_mfma_f32_16x16x32_bf16 v[56:59], v[16:19], v[68:71], 0
  v_mfma_f32_16x16x32_bf16 v[60:63], v[16:19], v[48:51], 0
  s_waitcnt lgkmcnt(8)
  ds_read_b64_tr_b16 v[32:33], v8 offset:18432
  ds_read_b64_tr_b16 v[34:35], v8 offset:19584
  ds_read_b128 v[96:99], v14 offset:8192
  ds_read_b128 v[100:103], v14 offset:9216
  v_mfma_f32_16x16x32_bf16 v[52:55], v[20:23], v[72:75], v[52:55]
  v_mfma_f32_16x16x32_bf16 v[56:59], v[20:23], v[76:79], v[56:59]
  v_mfma_f32_16x16x32_bf16 v[60:63], v[20:23], v[48:51], v[60:63]
  s_waitcnt lgkmcnt(8)
  ds_read_b64_tr_b16 v[36:37], v8 offset:20736
  ds_read_b64_tr_b16 v[38:39], v8 offset:21888
  ds_read_b128 v[104:107], v14 offset:10240
  ds_read_b128 v[108:111], v14 offset:11264
  v_mfma_f32_16x16x32_bf16 v[52:55], v[24:27], v[80:83], v[52:55]
  v_mfma_f32_16x16x32_bf16 v[56:59], v[24:27], v[84:87], v[56:59]
  v_mfma_f32_16x16x32_bf16 v[60:63], v[24:27], v[48:51], v[60:63]
  s_waitcnt lgkmcnt(8)
  ds_read_b64_tr_b16 v[40:41], v8 offset:27648
  ds_read_b64_tr_b16 v[42:43], v8 offset:28800
  ds_read_b128 v[112:115], v14 offset:12288
  ds_read_b128 v[116:119], v14 offset:13312
  v_mfma_f32_16x16x32_bf16 v[52:55], v[28:31], v[88:91], v[52:55]
  v_mfma_f32_16x16x32_bf16 v[56:59], v[28:31], v[92:95], v[56:59]
  v_mfma_f32_16x16x32_bf16 v[60:63], v[28:31], v[48:51], v[60:63]
  s_waitcnt lgkmcnt(8)
  ds_read_b64_tr_b16 v[44:45], v8 offset:29952
  ds_read_b64_tr_b16 v[46:47], v8 offset:31104
  ds_read_b128 v[120:123], v14 offset:14336
  ds_read_b128 v[124:127], v14 offset:15360
  v_mfma_f32_16x16x32_bf16 v[52:55], v[32:35], v[96:99], v[52:55]
  v_mfma_f32_16x16x32_bf16 v[56:59], v[32:35], v[100:103], v[56:59]
  v_mfma_f32_16x16x32_bf16 v[60:63], v[32:35], v[48:51], v[60:63]
  s_waitcnt lgkmcnt(8)
  v_mfma_f32_16x16x32_bf16 v[52:55], v[36:39], v[104:107], v[52:55]
  v_mfma_f32_16x16x32_bf16 v[56:59], v[36:39], v[108:111], v[56:59]
  v_mfma_f32_16x16x32_bf16 v[60:63], v[36:39], v[48:51], v[60:63]
  s_waitcnt lgkmcnt(4)
  v_mfma_f32_16x16x32_bf16 v[52:55], v[40:43], v[112:115], v[52:55]
  v_mfma_f32_16x16x32_bf16 v[56:59], v[40:43], v[116:119], v[56:59]
  v_mfma_f32_16x16x32_bf16 v[60:63], v[40:43], v[48:51], v[60:63]
  s_waitcnt lgkmcnt(0)
  v_mfma_f32_16x16x32_bf16 v[52:55], v[44:47], v[120:123], v[52:55]
  v_mfma_f32_16x16x32_bf16 v[56:59], v[44:47], v[124:127], v[56:59]
  v_mfma_f32_16x16x32_bf16 v[60:63], v[44:47], v[48:51], v[60:63]
  s_nop 7
  buffer_store_dwordx4 v[52:55], v2, s[32:35], s54 offen offset:0 sc1
  buffer_store_dwordx4 v[56:59], v2, s[32:35], s54 offen offset:1024 sc1
  buffer_store_dwordx4 v[60:63], v2, s[32:35], s55 offen offset:0 sc1
P1_FIN:
  s_and_b32 s56, s2, 7
  s_lshr_b32 s57, s2, 3
  s_and_b32 s49, s56, 4
  s_and_b32 s58, s57, 3
  s_add_u32 s49, s49, s58
  s_and_b32 s48, s56, 3
  s_lshl_b32 s48, s48, 2
  s_bfe_u32 s58, s57, 0x20002
  s_add_u32 s48, s48, s58
  s_lshl_b32 s48, s48, 1
  s_lshr_b32 s58, s57, 4
  s_add_u32 s48, s48, s58
  s_lshl_b32 s54, s48, 18
  s_add_u32 s54, s54, 4194304

  s_setprio 0
  s_lshl_b32 s53, s49, 3
  s_add_u32 s53, s53, s24
  s_lshl_b32 s53, s53, 6
  s_add_u32 s53, s53, s48
  s_lshl_b32 s53, s53, 10
  s_add_u32 s53, s53, 29360128
  v_and_b32 v6, 3, v1
  v_bfe_u32 v7, v1, 2, 1
  v_mov_b32 v8, 0x3f803f80
  v_cmp_gt_u32 vcc, 2, v6
  v_mov_b32 v120, 0x44444444
  v_mov_b32 v9, 0xeeeeeeee
  v_cndmask_b32 v8, 0, v8, vcc
  v_cmp_eq_u32 vcc, 1, v6
  s_nop 1
  v_cndmask_b32 v120, v120, v9, vcc
  v_cmp_eq_u32 vcc, 0, v7
  s_nop 1
  v_cndmask_b32 v116, 0, v8, vcc
  v_cndmask_b32 v117, 0, v8, vcc
  v_cndmask_b32 v118, v8, 0, vcc
  v_cndmask_b32 v119, v8, 0, vcc
  v_mov_b32 v4, v2
  v_mov_b32 v5, v2
  v_and_b32 v10, 15, v1
  v_lshlrev_b32 v10, 4, v10
  v_bfe_u32 v6, v1, 4, 1
  v_lshl_add_u32 v10, v6, 15, v10
  v_lshrrev_b32 v6, 5, v1
  v_lshl_add_u32 v10, v6, 8, v10
  s_lshl_b32 s51, s24, 11
  v_add_u32 v3, s51, v2
  s_add_u32 s50, s49, 1
  s_and_b32 s50, s50, 7
  s_lshl_b32 s50, s50, 15
  s_mov_b32 s55, 32768
  s_mov_b32 s62, 16
  v_mov_b32 v11, 163784
  v_mov_b32 v14, 1
  s_lshl_b32 s57, s48, 3
  s_add_u32 s57, s57, s49
  s_lshl_b32 s57, s57, 14
  s_add_u32 s57, s57, 0

  v_mov_b32 v96, 0
  v_mov_b32 v97, 0
  v_mov_b32 v98, 0
  v_mov_b32 v99, 0
  v_mov_b32 v100, 0
  v_mov_b32 v101, 0
  v_mov_b32 v102, 0
  v_mov_b32 v103, 0
  v_mov_b32 v104, 0
  v_mov_b32 v105, 0
  v_mov_b32 v106, 0
  v_mov_b32 v107, 0
  v_mov_b32 v108, 0
  v_mov_b32 v109, 0
  v_mov_b32 v110, 0
  v_mov_b32 v111, 0
  v_mov_b32 v112, 0
  v_mov_b32 v113, 0
  v_mov_b32 v114, 0
  v_mov_b32 v115, 0
  s_add_u32 s36, s22, s54
  s_addc_u32 s37, s23, 0
  s_mov_b32 s44, s36
  s_and_b32 s45, s37, 0xffff
  s_mov_b32 s46, 262144
  s_mov_b32 s47, 0x20000
  s_mov_b64 exec, 1
  ds_add_u32 v11, v14
  s_mov_b64 exec, -1
  v_mov_b32 v9, 163776
  s_mov_b32 s57, 0
SP25:
  ds_read_b32 v12, v9 offset:4
  s_add_u32 s57, s57, 1
  s_waitcnt lgkmcnt(0)
  v_readfirstlane_b32 s56, v12
  s_cmp_gt_u32 s57, 2000000
  s_cbranch_scc1 SP25_X
  s_cmp_ge_u32 s56, 4
  s_cbranch_scc1 SP25_X

  s_sleep 1
  s_branch SP25
SP25_X:
  v_add_u32 v9, 139264, v3
  ds_read_b128 v[16:19], v9 offset:0
  ds_read_b128 v[20:23], v9 offset:1024
  ds_read_b128 v[124:127], v4 offset:0
  ds_read_b128 v[128:131], v4 offset:1024
  ds_read_b128 v[132:135], v4 offset:4096
  ds_read_b128 v[136:139], v4 offset:5120
  s_waitcnt lgkmcnt(0)
  v_mfma_f32_32x32x16_bf16 v[48:63], v[124:127], v[16:19], 0
  v_mfma_f32_32x32x16_bf16 v[48:63], v[128:131], v[20:23], v[48:63]
  s_nop 11
  v_max3_f32 v6, v48, v49, v50
  v_max3_f32 v6, v6, v51, v52
  v_max3_f32 v6, v6, v53, v54
  v_max3_f32 v6, v6, v55, v56
  v_max3_f32 v6, v6, v57, v58
  v_max3_f32 v6, v6, v59, v60
  v_max3_f32 v6, v6, v61, v62
  v_max_f32 v6, v6, v63
  v_mov_b32 v7, v6
  v_mov_b32 v8, v6
  s_nop 1
  v_permlane32_swap_b32 v7, v8
  s_nop 1
  v_max_f32 v6, v7, v8
  v_sub_f32 v32, 0, v6
  v_sub_f32 v33, 0, v6
  v_sub_f32 v34, 0, v6
  v_sub_f32 v35, 0, v6
  v_sub_f32 v36, 0, v6
  v_sub_f32 v37, 0, v6
  v_sub_f32 v38, 0, v6
  v_sub_f32 v39, 0, v6
  v_sub_f32 v40, 0, v6
  v_sub_f32 v41, 0, v6
  v_sub_f32 v42, 0, v6
  v_sub_f32 v43, 0, v6
  v_sub_f32 v44, 0, v6
  v_sub_f32 v45, 0, v6
  v_sub_f32 v46, 0, v6
  v_sub_f32 v47, 0, v6
  v_sub_f32 v48, v48, v6
  v_sub_f32 v49, v49, v6
  v_sub_f32 v50, v50, v6
  v_sub_f32 v51, v51, v6
  v_sub_f32 v52, v52, v6
  v_sub_f32 v53, v53, v6
  v_sub_f32 v54, v54, v6
  v_sub_f32 v55, v55, v6
  v_sub_f32 v56, v56, v6
  v_sub_f32 v57, v57, v6
  v_sub_f32 v58, v58, v6
  v_sub_f32 v59, v59, v6
  v_sub_f32 v60, v60, v6
  v_sub_f32 v61, v61, v6
  v_sub_f32 v62, v62, v6
  v_sub_f32 v63, v63, v6
  ds_read_b128 v[124:127], v4 offset:8192
  ds_read_b128 v[128:131], v4 offset:9216
  ds_read_b128 v[140:143], v4 offset:2048
  ds_read_b128 v[144:147], v4 offset:3072
  v_mfma_f32_32x32x16_bf16 v[64:79], v[132:135], v[16:19], v[32:47]
  v_exp_f32 v48, v48
  v_exp_f32 v49, v49
  v_exp_f32 v50, v50
  v_exp_f32 v51, v51
  v_exp_f32 v52, v52
  v_exp_f32 v53, v53
  v_cvt_pk_bf16_f32 v80, v48, v49
  v_cvt_pk_bf16_f32 v81, v50, v51
  v_mfma_f32_32x32x16_bf16 v[64:79], v[136:139], v[20:23], v[64:79]
  v_exp_f32 v54, v54
  v_exp_f32 v55, v55
  v_exp_f32 v56, v56
  v_cvt_pk_bf16_f32 v82, v52, v53
  v_cvt_pk_bf16_f32 v83, v54, v55
  v_exp_f32 v57, v57
  v_exp_f32 v58, v58
  v_exp_f32 v59, v59
  v_exp_f32 v60, v60
  v_cvt_pk_bf16_f32 v84, v56, v57
  v_cvt_pk_bf16_f32 v85, v58, v59
  v_exp_f32 v61, v61
  v_exp_f32 v62, v62
  v_exp_f32 v63, v63
  v_cvt_pk_bf16_f32 v86, v60, v61
  s_waitcnt lgkmcnt(0)
  v_cvt_pk_bf16_f32 v87, v62, v63
  ds_read_b128 v[132:135], v4 offset:12288
  ds_read_b128 v[136:139], v4 offset:13312
  ds_read_b128 v[148:151], v4 offset:6144
  ds_read_b128 v[152:155], v4 offset:7168
  v_mfma_f32_32x32x16_bf16 v[48:63], v[124:127], v[16:19], v[32:47]
  v_exp_f32 v64, v64
  v_exp_f32 v65, v65
  v_exp_f32 v66, v66
  v_mfma_f32_32x32x16_bf16 v[96:111], v[140:143], v[80:83], v[96:111]
  s_waitcnt vmcnt(0)
  s_mov_b64 exec, 1
  ds_add_u32 v11, v14
  s_mov_b64 exec, -1
  v_exp_f32 v67, v67
  v_exp_f32 v68, v68
  v_exp_f32 v69, v69
  v_cvt_pk_bf16_f32 v88, v64, v65
  v_cvt_pk_bf16_f32 v89, v66, v67
  v_mfma_f32_32x32x16_bf16 v[48:63], v[128:131], v[20:23], v[48:63]
  v_exp_f32 v70, v70
  v_exp_f32 v71, v71
  v_exp_f32 v72, v72
  v_cvt_pk_bf16_f32 v90, v68, v69
  v_cvt_pk_bf16_f32 v91, v70, v71
  v_mfma_f32_32x32x16_bf16 v[96:111], v[144:147], v[84:87], v[96:111]
  v_exp_f32 v73, v73
  v_exp_f32 v74, v74
  v_exp_f32 v75, v75
  v_exp_f32 v76, v76
  v_cvt_pk_bf16_f32 v92, v72, v73
  v_cvt_pk_bf16_f32 v93, v74, v75
  v_smfmac_f32_16x16x64_bf16 v[112:115], v[116:119], v[80:87], v120
  v_exp_f32 v77, v77
  v_exp_f32 v78, v78
  v_exp_f32 v79, v79
  v_cvt_pk_bf16_f32 v94, v76, v77
  s_waitcnt lgkmcnt(0)
  v_cvt_pk_bf16_f32 v95, v78, v79
  s_mov_b32 s57, 0
SP26:
  ds_read_b32 v12, v11 offset:0
  s_add_u32 s57, s57, 1
  s_waitcnt lgkmcnt(0)
  v_readfirstlane_b32 s56, v12
  s_cmp_gt_u32 s57, 2000000
  s_cbranch_scc1 SP26_X
  s_cmp_ge_u32 s56, 8
  s_cbranch_scc1 SP26_X

  s_branch SP26
SP26_X:
  s_mov_b32 s57, 0
SP27:
  ds_read_b32 v12, v11 offset:4
  s_add_u32 s57, s57, 1
  s_waitcnt lgkmcnt(0)
  v_readfirstlane_b32 s56, v12
  s_cmp_gt_u32 s57, 2000000
  s_cbranch_scc1 SP27_X
  s_cmp_ge_u32 s56, 2
  s_cbranch_scc1 SP27_X

  s_sleep 1
  s_branch SP27
SP27_X:
  s_add_u32 m0, s51, s55
  s_add_u32 s55, s55, 16384
  buffer_load_dwordx4 v3, s[44:47], s50 offen sc1 lds
  buffer_load_dwordx4 v3, s[44:47], s50 offen offset:1024 sc1 lds
  s_and_b32 s55, s55, 0xffff
  s_add_u32 s50, s50, 16384
  s_and_b32 s50, s50, 0x3ffff
  ds_read_b64 v[12:13], v11
  s_waitcnt lgkmcnt(0)
  s_mov_b32 s52, 1
P2_LOOP:
  v_readfirstlane_b32 s56, v12
  v_readfirstlane_b32 s57, v13
  v_mov_b32 v5, v4
  v_add_u32 v4, 16384, v4
  v_and_b32 v4, 0xffff, v4
  s_lshr_b32 s63, s52, 1
  s_add_u32 s63, s63, 2
  s_min_u32 s63, s63, 8
  s_cmp_lt_u32 s52, 14
  s_cselect_b32 s46, 262144, 0
  s_cmp_ge_u32 s56, s62
  s_cbranch_scc0 P2_SPIN
  s_cmp_ge_u32 s57, s63
  s_cbranch_scc0 P2_SPIN

P2_GO:
  ds_read_b128 v[124:127], v4 offset:0
  ds_read_b128 v[128:131], v4 offset:1024
  ds_read_b128 v[140:143], v5 offset:10240
  ds_read_b128 v[144:147], v5 offset:11264
  v_mfma_f32_32x32x16_bf16 v[64:79], v[132:135], v[16:19], v[32:47]
  v_exp_f32 v48, v48
  v_exp_f32 v49, v49
  v_exp_f32 v50, v50
  v_mfma_f32_32x32x16_bf16 v[96:111], v[148:151], v[88:91], v[96:111]
  s_add_u32 m0, s51, s55
  s_add_u32 s55, s55, 16384
  buffer_load_dwordx4 v3, s[44:47], s50 offen sc1 lds
  buffer_load_dwordx4 v3, s[44:47], s50 offen offset:1024 sc1 lds
  s_and_b32 s55, s55, 0xffff
  s_add_u32 s50, s50, 16384
  s_and_b32 s50, s50, 0x3ffff
  v_exp_f32 v51, v51
  v_exp_f32 v52, v52
  v_exp_f32 v53, v53
  v_cvt_pk_bf16_f32 v80, v48, v49
  v_cvt_pk_bf16_f32 v81, v50, v51
  v_mfma_f32_32x32x16_bf16 v[64:79], v[136:139], v[20:23], v[64:79]
  v_exp_f32 v54, v54
  v_exp_f32 v55, v55
  v_exp_f32 v56, v56
  v_cvt_pk_bf16_f32 v82, v52, v53
  v_cvt_pk_bf16_f32 v83, v54, v55
  v_mfma_f32_32x32x16_bf16 v[96:111], v[152:155], v[92:95], v[96:111]
  v_exp_f32 v57, v57
  v_exp_f32 v58, v58
  v_exp_f32 v59, v59
  v_exp_f32 v60, v60
  v_cvt_pk_bf16_f32 v84, v56, v57
  v_cvt_pk_bf16_f32 v85, v58, v59
  v_smfmac_f32_16x16x64_bf16 v[112:115], v[116:119], v[88:95], v120
  v_exp_f32 v61, v61
  v_exp_f32 v62, v62
  v_exp_f32 v63, v63
  v_cvt_pk_bf16_f32 v86, v60, v61
  s_waitcnt lgkmcnt(0)
  v_cvt_pk_bf16_f32 v87, v62, v63
  ds_read_b128 v[132:135], v4 offset:4096
  ds_read_b128 v[136:139], v4 offset:5120
  ds_read_b128 v[148:151], v5 offset:14336
  ds_read_b128 v[152:155], v5 offset:15360
  v_mfma_f32_32x32x16_bf16 v[48:63], v[124:127], v[16:19], v[32:47]
  v_exp_f32 v64, v64
  v_exp_f32 v65, v65
  v_exp_f32 v66, v66
  v_mfma_f32_32x32x16_bf16 v[96:111], v[140:143], v[80:83], v[96:111]
  v_exp_f32 v67, v67
  v_exp_f32 v68, v68
  v_exp_f32 v69, v69
  v_cvt_pk_bf16_f32 v88, v64, v65
  v_cvt_pk_bf16_f32 v89, v66, v67
  v_mfma_f32_32x32x16_bf16 v[48:63], v[128:131], v[20:23], v[48:63]
  v_exp_f32 v70, v70
  v_exp_f32 v71, v71
  v_exp_f32 v72, v72
  v_cvt_pk_bf16_f32 v90, v68, v69
  v_cvt_pk_bf16_f32 v91, v70, v71
  v_mfma_f32_32x32x16_bf16 v[96:111], v[144:147], v[84:87], v[96:111]
  v_exp_f32 v73, v73
  v_exp_f32 v74, v74
  v_exp_f32 v75, v75
  v_exp_f32 v76, v76
  v_cvt_pk_bf16_f32 v92, v72, v73
  v_cvt_pk_bf16_f32 v93, v74, v75
  v_smfmac_f32_16x16x64_bf16 v[112:115], v[116:119], v[80:87], v120
  v_exp_f32 v77, v77
  v_exp_f32 v78, v78
  v_exp_f32 v79, v79
  v_cvt_pk_bf16_f32 v94, v76, v77
  s_waitcnt lgkmcnt(0)
  v_cvt_pk_bf16_f32 v95, v78, v79
  ds_read_b128 v[124:127], v4 offset:8192
  ds_read_b128 v[128:131], v4 offset:9216
  ds_read_b128 v[140:143], v4 offset:2048
  ds_read_b128 v[144:147], v4 offset:3072
  v_mfma_f32_32x32x16_bf16 v[64:79], v[132:135], v[16:19], v[32:47]
  v_exp_f32 v48, v48
  v_exp_f32 v49, v49
  v_exp_f32 v50, v50
  v_mfma_f32_32x32x16_bf16 v[96:111], v[148:151], v[88:91], v[96:111]
  s_waitcnt vmcnt(2)
  s_mov_b64 exec, 1
  ds_add_u32 v11, v14
  s_mov_b64 exec, -1
  v_exp_f32 v51, v51
  v_exp_f32 v52, v52
  v_exp_f32 v53, v53
  v_cvt_pk_bf16_f32 v80, v48, v49
  v_cvt_pk_bf16_f32 v81, v50, v51
  v_mfma_f32_32x32x16_bf16 v[64:79], v[136:139], v[20:23], v[64:79]
  v_exp_f32 v54, v54
  v_exp_f32 v55, v55
  v_exp_f32 v56, v56
  v_cvt_pk_bf16_f32 v82, v52, v53
  v_cvt_pk_bf16_f32 v83, v54, v55
  v_mfma_f32_32x32x16_bf16 v[96:111], v[152:155], v[92:95], v[96:111]
  v_exp_f32 v57, v57
  v_exp_f32 v58, v58
  v_exp_f32 v59, v59
  v_exp_f32 v60, v60
  v_cvt_pk_bf16_f32 v84, v56, v57
  v_cvt_pk_bf16_f32 v85, v58, v59
  v_smfmac_f32_16x16x64_bf16 v[112:115], v[116:119], v[88:95], v120
  v_exp_f32 v61, v61
  v_exp_f32 v62, v62
  v_exp_f32 v63, v63
  v_cvt_pk_bf16_f32 v86, v60, v61
  s_waitcnt lgkmcnt(0)
  v_cvt_pk_bf16_f32 v87, v62, v63
  ds_read_b128 v[132:135], v4 offset:12288
  ds_read_b128 v[136:139], v4 offset:13312
  ds_read_b128 v[148:151], v4 offset:6144
  ds_read_b128 v[152:155], v4 offset:7168
  v_mfma_f32_32x32x16_bf16 v[48:63], v[124:127], v[16:19], v[32:47]
  v_exp_f32 v64, v64
  v_exp_f32 v65, v65
  v_exp_f32 v66, v66
  v_mfma_f32_32x32x16_bf16 v[96:111], v[140:143], v[80:83], v[96:111]
  v_exp_f32 v67, v67
  v_exp_f32 v68, v68
  v_exp_f32 v69, v69
  v_cvt_pk_bf16_f32 v88, v64, v65
  v_cvt_pk_bf16_f32 v89, v66, v67
  v_mfma_f32_32x32x16_bf16 v[48:63], v[128:131], v[20:23], v[48:63]
  v_exp_f32 v70, v70
  v_exp_f32 v71, v71
  v_exp_f32 v72, v72
  v_cvt_pk_bf16_f32 v90, v68, v69
  v_cvt_pk_bf16_f32 v91, v70, v71
  v_mfma_f32_32x32x16_bf16 v[96:111], v[144:147], v[84:87], v[96:111]
  v_exp_f32 v73, v73
  v_exp_f32 v74, v74
  v_exp_f32 v75, v75
  v_exp_f32 v76, v76
  v_cvt_pk_bf16_f32 v92, v72, v73
  v_cvt_pk_bf16_f32 v93, v74, v75
  v_smfmac_f32_16x16x64_bf16 v[112:115], v[116:119], v[80:87], v120
  ds_read_b64 v[12:13], v11
  v_exp_f32 v77, v77
  v_exp_f32 v78, v78
  v_exp_f32 v79, v79
  v_cvt_pk_bf16_f32 v94, v76, v77
  s_waitcnt lgkmcnt(0)
  v_cvt_pk_bf16_f32 v95, v78, v79
  s_add_u32 s62, s62, 8
  s_add_u32 s52, s52, 1
  s_cmp_lt_u32 s52, 16
  s_cbranch_scc1 P2_LOOP

  ds_read_b128 v[140:143], v4 offset:10240
  ds_read_b128 v[144:147], v4 offset:11264
  v_mfma_f32_32x32x16_bf16 v[64:79], v[132:135], v[16:19], v[32:47]
  v_exp_f32 v48, v48
  v_exp_f32 v49, v49
  v_exp_f32 v50, v50
  v_mfma_f32_32x32x16_bf16 v[96:111], v[148:151], v[88:91], v[96:111]
  v_exp_f32 v51, v51
  v_exp_f32 v52, v52
  v_exp_f32 v53, v53
  v_cvt_pk_bf16_f32 v80, v48, v49
  v_cvt_pk_bf16_f32 v81, v50, v51
  v_mfma_f32_32x32x16_bf16 v[64:79], v[136:139], v[20:23], v[64:79]
  v_exp_f32 v54, v54
  v_exp_f32 v55, v55
  v_exp_f32 v56, v56
  v_cvt_pk_bf16_f32 v82, v52, v53
  v_cvt_pk_bf16_f32 v83, v54, v55
  v_mfma_f32_32x32x16_bf16 v[96:111], v[152:155], v[92:95], v[96:111]
  v_exp_f32 v57, v57
  v_exp_f32 v58, v58
  v_exp_f32 v59, v59
  v_exp_f32 v60, v60
  v_cvt_pk_bf16_f32 v84, v56, v57
  v_cvt_pk_bf16_f32 v85, v58, v59
  v_smfmac_f32_16x16x64_bf16 v[112:115], v[116:119], v[88:95], v120
  v_exp_f32 v61, v61
  v_exp_f32 v62, v62
  v_exp_f32 v63, v63
  v_cvt_pk_bf16_f32 v86, v60, v61
  s_waitcnt lgkmcnt(0)
  v_cvt_pk_bf16_f32 v87, v62, v63
  ds_read_b128 v[148:151], v4 offset:14336
  ds_read_b128 v[152:155], v4 offset:15360
  v_exp_f32 v64, v64
  v_exp_f32 v65, v65
  v_exp_f32 v66, v66
  v_mfma_f32_32x32x16_bf16 v[96:111], v[140:143], v[80:83], v[96:111]
  v_exp_f32 v67, v67
  v_exp_f32 v68, v68
  v_exp_f32 v69, v69
  v_cvt_pk_bf16_f32 v88, v64, v65
  v_cvt_pk_bf16_f32 v89, v66, v67
  v_exp_f32 v70, v70
  v_exp_f32 v71, v71
  v_exp_f32 v72, v72
  v_cvt_pk_bf16_f32 v90, v68, v69
  v_cvt_pk_bf16_f32 v91, v70, v71
  v_mfma_f32_32x32x16_bf16 v[96:111], v[144:147], v[84:87], v[96:111]
  v_exp_f32 v73, v73
  v_exp_f32 v74, v74
  v_exp_f32 v75, v75
  v_exp_f32 v76, v76
  v_cvt_pk_bf16_f32 v92, v72, v73
  v_cvt_pk_bf16_f32 v93, v74, v75
  v_smfmac_f32_16x16x64_bf16 v[112:115], v[116:119], v[80:87], v120
  v_exp_f32 v77, v77
  v_exp_f32 v78, v78
  v_exp_f32 v79, v79
  v_cvt_pk_bf16_f32 v94, v76, v77
  s_waitcnt lgkmcnt(0)
  v_cvt_pk_bf16_f32 v95, v78, v79
  s_nop 1
  v_mfma_f32_32x32x16_bf16 v[96:111], v[148:151], v[88:91], v[96:111]
  v_mfma_f32_32x32x16_bf16 v[96:111], v[152:155], v[92:95], v[96:111]
  v_smfmac_f32_16x16x64_bf16 v[112:115], v[116:119], v[88:95], v120
  s_waitcnt lgkmcnt(0)
  s_nop 9
  v_add_f32 v6, v112, v113
  v_mul_f32 v7, 0, v96
  v_fma_f32 v7, v97, 0, v7
  v_fma_f32 v7, v98, 0, v7
  v_fma_f32 v7, v99, 0, v7
  v_fma_f32 v7, v100, 0, v7
  v_fma_f32 v7, v101, 0, v7
  v_fma_f32 v7, v102, 0, v7
  v_fma_f32 v7, v103, 0, v7
  v_fma_f32 v7, v104, 0, v7
  v_fma_f32 v7, v105, 0, v7
  v_fma_f32 v7, v106, 0, v7
  v_fma_f32 v7, v107, 0, v7
  v_fma_f32 v7, v108, 0, v7
  v_fma_f32 v7, v109, 0, v7
  v_fma_f32 v7, v110, 0, v7
  v_fma_f32 v7, v111, 0, v7
  v_add_f32 v7, v7, v6
  s_mov_b32 s56, 1904214016
  v_cmp_ngt_f32 vcc, s56, v7
  s_cbranch_vccnz P2_SLOW

P2_FIN:
  v_rcp_f32 v7, v6
  s_nop 0
  v_mul_f32 v96, v7, v96
  v_mul_f32 v97, v7, v97
  v_mul_f32 v98, v7, v98
  v_mul_f32 v99, v7, v99
  v_mul_f32 v100, v7, v100
  v_mul_f32 v101, v7, v101
  v_mul_f32 v102, v7, v102
  v_mul_f32 v103, v7, v103
  v_mul_f32 v104, v7, v104
  v_mul_f32 v105, v7, v105
  v_mul_f32 v106, v7, v106
  v_mul_f32 v107, v7, v107
  v_mul_f32 v108, v7, v108
  v_mul_f32 v109, v7, v109
  v_mul_f32 v110, v7, v110
  v_mul_f32 v111, v7, v111
  v_cvt_pk_bf16_f32 v80, v96, v97
  v_cvt_pk_bf16_f32 v81, v98, v99
  v_cvt_pk_bf16_f32 v82, v100, v101
  v_cvt_pk_bf16_f32 v83, v102, v103
  v_cvt_pk_bf16_f32 v84, v104, v105
  v_cvt_pk_bf16_f32 v85, v106, v107
  v_cvt_pk_bf16_f32 v86, v108, v109
  v_cvt_pk_bf16_f32 v87, v110, v111
  buffer_store_dwordx4 v[80:83], v10, s[32:35], s53 offen sc1
  buffer_store_dwordx4 v[84:87], v10, s[32:35], s53 offen offset:512 sc1
  s_lshl_b32 s56, s49, 5
  s_add_u32 s56, s56, s48
  s_lshl_b32 s56, s56, 7
  s_add_u32 s64, s56, 37814272
  s_setprio 0

  s_and_b32 s60, s2, 7
  s_lshr_b32 s61, s2, 3
  s_lshr_b32 s48, s60, 2
  s_lshr_b32 s49, s60, 1
  s_and_b32 s49, s49, 1
  s_lshl_b32 s49, s49, 3
  s_and_b32 s62, s61, 7
  s_add_u32 s49, s49, s62
  s_and_b32 s50, s60, 1
  s_lshl_b32 s50, s50, 2
  s_lshr_b32 s62, s61, 3
  s_add_u32 s50, s50, s62

  s_and_b32 s51, s24, 1
  s_lshr_b32 s52, s24, 1
  s_and_b32 s52, s52, 1
  s_lshr_b32 s53, s24, 2
  s_lshl_b32 s60, s51, 13
  s_lshl_b32 s61, s53, 10
  s_add_u32 s60, s60, s61
  v_add_u32 v5, s60, v2
  v_bfe_u32 v10, v1, 2, 3
  v_lshrrev_b32 v11, 5, v1
  v_lshl_add_u32 v11, v11, 4, v10
  v_lshlrev_b32 v11, 8, v11
  v_and_b32 v12, 3, v1
  v_lshl_add_u32 v11, v12, 3, v11
  s_lshl_b32 s60, s53, 13
  s_add_u32 s60, s60, 65536
  v_add_u32 v11, s60, v11
  s_lshl_b32 s61, s52, 2
  v_xor_b32 v10, s61, v10

  v_xor_b32 v12, 0, v10
  v_lshl_add_u32 v6, v12, 5, v11
  v_xor_b32 v12, 1, v10
  v_lshl_add_u32 v7, v12, 5, v11
  v_xor_b32 v12, 2, v10
  v_lshl_add_u32 v8, v12, 5, v11
  v_xor_b32 v12, 3, v10
  v_lshl_add_u32 v9, v12, 5, v11
  v_mov_b32 v80, 0
  v_mov_b32 v81, 0
  v_mov_b32 v82, 0
  v_mov_b32 v83, 0
  v_mov_b32 v84, 0
  v_mov_b32 v85, 0
  v_mov_b32 v86, 0
  v_mov_b32 v87, 0
  v_mov_b32 v88, 0
  v_mov_b32 v89, 0
  v_mov_b32 v90, 0
  v_mov_b32 v91, 0
  v_mov_b32 v92, 0
  v_mov_b32 v93, 0
  v_mov_b32 v94, 0
  v_mov_b32 v95, 0
  v_mov_b32 v96, 0
  v_mov_b32 v97, 0
  v_mov_b32 v98, 0
  v_mov_b32 v99, 0
  v_mov_b32 v100, 0
  v_mov_b32 v101, 0
  v_mov_b32 v102, 0
  v_mov_b32 v103, 0
  v_mov_b32 v104, 0
  v_mov_b32 v105, 0
  v_mov_b32 v106, 0
  v_mov_b32 v107, 0
  v_mov_b32 v108, 0
  v_mov_b32 v109, 0
  v_mov_b32 v110, 0
  v_mov_b32 v111, 0
  v_mov_b32 v112, 0
  v_mov_b32 v113, 0
  v_mov_b32 v114, 0
  v_mov_b32 v115, 0
  v_mov_b32 v116, 0
  v_mov_b32 v117, 0
  v_mov_b32 v118, 0
  v_mov_b32 v119, 0
  v_mov_b32 v120, 0
  v_mov_b32 v121, 0
  v_mov_b32 v122, 0
  v_mov_b32 v123, 0
  v_mov_b32 v124, 0
  v_mov_b32 v125, 0
  v_mov_b32 v126, 0
  v_mov_b32 v127, 0
  v_mov_b32 v128, 0
  v_mov_b32 v129, 0
  v_mov_b32 v130, 0
  v_mov_b32 v131, 0
  v_mov_b32 v132, 0
  v_mov_b32 v133, 0
  v_mov_b32 v134, 0
  v_mov_b32 v135, 0
  v_mov_b32 v136, 0
  v_mov_b32 v137, 0
  v_mov_b32 v138, 0
  v_mov_b32 v139, 0
  v_mov_b32 v140, 0
  v_mov_b32 v141, 0
  v_mov_b32 v142, 0
  v_mov_b32 v143, 0
  v_mov_b32 v48, 0
  v_mov_b32 v49, 0
  v_mov_b32 v50, 0
  v_mov_b32 v51, 0
  v_mov_b32 v52, 0
  v_mov_b32 v53, 0
  v_mov_b32 v54, 0
  v_mov_b32 v55, 0
  v_mov_b32 v56, 0
  v_mov_b32 v57, 0
  v_mov_b32 v58, 0
  v_mov_b32 v59, 0
  v_mov_b32 v60, 0
  v_mov_b32 v61, 0
  v_mov_b32 v62, 0
  v_mov_b32 v63, 0
  v_mov_b32 v64, 0
  v_mov_b32 v65, 0
  v_mov_b32 v66, 0
  v_mov_b32 v67, 0
  v_mov_b32 v68, 0
  v_mov_b32 v69, 0
  v_mov_b32 v70, 0
  v_mov_b32 v71, 0
  v_mov_b32 v72, 0
  v_mov_b32 v73, 0
  v_mov_b32 v74, 0
  v_mov_b32 v75, 0
  v_mov_b32 v76, 0
  v_mov_b32 v77, 0
  v_mov_b32 v78, 0
  v_mov_b32 v79, 0
  s_mov_b32 s58, 0
  s_mov_b32 s44, s18
  s_and_b32 s45, s19, 0xffff
  s_mov_b32 s46, 8388608
  s_mov_b32 s47, 0x20000
  s_waitcnt vmcnt(0)
  v_mov_b32 v160, 163776
  v_mov_b32 v161, 1
  s_mov_b64 exec, 1
  ds_add_rtn_u32 v164, v160, v161 offset:20
  ds_read_b64 v[162:163], v160 offset:32
  v_mov_b32 v160, 0
  s_waitcnt lgkmcnt(0)
  v_readfirstlane_b32 s61, v164
  s_nop 0
  s_cmp_lg_u32 s61, 7
  s_cbranch_scc1 LW28
  buffer_store_dwordx2 v[162:163], v160, s[32:35], s64 offen sc0 sc1

LW28:
  s_mov_b64 exec, -1
  s_barrier
P3_LOOP:
  s_waitcnt lgkmcnt(0)
  s_barrier
  ds_read_b128 v[16:19], v5 offset:0
  ds_read_b64_tr_b16 v[32:33], v6 offset:0
  v_mfma_f32_16x16x32_bf16 v[80:83], v[64:67], v[48:51], v[80:83]
  ds_read_b64_tr_b16 v[34:35], v6 offset:2048
  ds_read_b128 v[20:23], v5 offset:2048
  v_mfma_f32_16x16x32_bf16 v[84:87], v[64:67], v[52:55], v[84:87]
  ds_read_b64_tr_b16 v[36:37], v7 offset:0
  ds_read_b64_tr_b16 v[38:39], v7 offset:2048
  v_mfma_f32_16x16x32_bf16 v[88:91], v[64:67], v[56:59], v[88:91]
  ds_read_b128 v[24:27], v5 offset:4096
  ds_read_b64_tr_b16 v[40:41], v8 offset:0
  v_mfma_f32_16x16x32_bf16 v[92:95], v[64:67], v[60:63], v[92:95]
  ds_read_b64_tr_b16 v[42:43], v8 offset:2048
  ds_read_b128 v[28:31], v5 offset:6144
  v_mfma_f32_16x16x32_bf16 v[96:99], v[68:71], v[48:51], v[96:99]
  ds_read_b64_tr_b16 v[44:45], v9 offset:0
  ds_read_b64_tr_b16 v[46:47], v9 offset:2048
  v_mfma_f32_16x16x32_bf16 v[100:103], v[68:71], v[52:55], v[100:103]
  v_mfma_f32_16x16x32_bf16 v[104:107], v[68:71], v[56:59], v[104:107]
  v_mfma_f32_16x16x32_bf16 v[108:111], v[68:71], v[60:63], v[108:111]
  v_mfma_f32_16x16x32_bf16 v[112:115], v[72:75], v[48:51], v[112:115]
  v_mfma_f32_16x16x32_bf16 v[116:119], v[72:75], v[52:55], v[116:119]
  v_mfma_f32_16x16x32_bf16 v[120:123], v[72:75], v[56:59], v[120:123]
  v_mfma_f32_16x16x32_bf16 v[124:127], v[72:75], v[60:63], v[124:127]
  v_mfma_f32_16x16x32_bf16 v[128:131], v[76:79], v[48:51], v[128:131]
  v_mfma_f32_16x16x32_bf16 v[132:135], v[76:79], v[52:55], v[132:135]
  v_mfma_f32_16x16x32_bf16 v[136:139], v[76:79], v[56:59], v[136:139]
  v_mfma_f32_16x16x32_bf16 v[140:143], v[76:79], v[60:63], v[140:143]
  s_waitcnt lgkmcnt(0)
  s_barrier
  ds_read_b128 v[48:51], v5 offset:16384
  ds_read_b64_tr_b16 v[64:65], v6 offset:16384
  v_mfma_f32_16x16x32_bf16 v[80:83], v[32:35], v[16:19], v[80:83]
  ds_read_b64_tr_b16 v[66:67], v6 offset:18432
  ds_read_b128 v[52:55], v5 offset:18432
  v_mfma_f32_16x16x32_bf16 v[84:87], v[32:35], v[20:23], v[84:87]
  ds_read_b64_tr_b16 v[68:69], v7 offset:16384
  ds_read_b64_tr_b16 v[70:71], v7 offset:18432
  v_mfma_f32_16x16x32_bf16 v[88:91], v[32:35], v[24:27], v[88:91]
  ds_read_b128 v[56:59], v5 offset:20480
  ds_read_b64_tr_b16 v[72:73], v8 offset:16384
  v_mfma_f32_16x16x32_bf16 v[92:95], v[32:35], v[28:31], v[92:95]
  ds_read_b64_tr_b16 v[74:75], v8 offset:18432
  ds_read_b128 v[60:63], v5 offset:22528
  v_mfma_f32_16x16x32_bf16 v[96:99], v[36:39], v[16:19], v[96:99]
  ds_read_b64_tr_b16 v[76:77], v9 offset:16384
  ds_read_b64_tr_b16 v[78:79], v9 offset:18432
  v_mfma_f32_16x16x32_bf16 v[100:103], v[36:39], v[20:23], v[100:103]
  v_mfma_f32_16x16x32_bf16 v[104:107], v[36:39], v[24:27], v[104:107]
  v_mfma_f32_16x16x32_bf16 v[108:111], v[36:39], v[28:31], v[108:111]
  v_mfma_f32_16x16x32_bf16 v[112:115], v[40:43], v[16:19], v[112:115]
  v_mfma_f32_16x16x32_bf16 v[116:119], v[40:43], v[20:23], v[116:119]
  v_mfma_f32_16x16x32_bf16 v[120:123], v[40:43], v[24:27], v[120:123]
  v_mfma_f32_16x16x32_bf16 v[124:127], v[40:43], v[28:31], v[124:127]
  v_mfma_f32_16x16x32_bf16 v[128:131], v[44:47], v[16:19], v[128:131]
  v_mfma_f32_16x16x32_bf16 v[132:135], v[44:47], v[20:23], v[132:135]
  v_mfma_f32_16x16x32_bf16 v[136:139], v[44:47], v[24:27], v[136:139]
  v_mfma_f32_16x16x32_bf16 v[140:143], v[44:47], v[28:31], v[140:143]
  s_waitcnt lgkmcnt(0)
  s_barrier
  ds_read_b128 v[16:19], v5 offset:32768
  ds_read_b64_tr_b16 v[32:33], v6 offset:32768
  v_mfma_f32_16x16x32_bf16 v[80:83], v[64:67], v[48:51], v[80:83]
  ds_read_b64_tr_b16 v[34:35], v6 offset:34816
  ds_read_b128 v[20:23], v5 offset:34816
  v_mfma_f32_16x16x32_bf16 v[84:87], v[64:67], v[52:55], v[84:87]
  ds_read_b64_tr_b16 v[36:37], v7 offset:32768
  ds_read_b64_tr_b16 v[38:39], v7 offset:34816
  v_mfma_f32_16x16x32_bf16 v[88:91], v[64:67], v[56:59], v[88:91]
  ds_read_b128 v[24:27], v5 offset:36864
  ds_read_b64_tr_b16 v[40:41], v8 offset:32768
  v_mfma_f32_16x16x32_bf16 v[92:95], v[64:67], v[60:63], v[92:95]
  ds_read_b64_tr_b16 v[42:43], v8 offset:34816
  ds_read_b128 v[28:31], v5 offset:38912
  v_mfma_f32_16x16x32_bf16 v[96:99], v[68:71], v[48:51], v[96:99]
  ds_read_b64_tr_b16 v[44:45], v9 offset:32768
  ds_read_b64_tr_b16 v[46:47], v9 offset:34816
  v_mfma_f32_16x16x32_bf16 v[100:103], v[68:71], v[52:55], v[100:103]
  v_mfma_f32_16x16x32_bf16 v[104:107], v[68:71], v[56:59], v[104:107]
  v_mfma_f32_16x16x32_bf16 v[108:111], v[68:71], v[60:63], v[108:111]
  v_mfma_f32_16x16x32_bf16 v[112:115], v[72:75], v[48:51], v[112:115]
  v_mfma_f32_16x16x32_bf16 v[116:119], v[72:75], v[52:55], v[116:119]
  v_mfma_f32_16x16x32_bf16 v[120:123], v[72:75], v[56:59], v[120:123]
  v_mfma_f32_16x16x32_bf16 v[124:127], v[72:75], v[60:63], v[124:127]
  v_mfma_f32_16x16x32_bf16 v[128:131], v[76:79], v[48:51], v[128:131]
  v_mfma_f32_16x16x32_bf16 v[132:135], v[76:79], v[52:55], v[132:135]
  v_mfma_f32_16x16x32_bf16 v[136:139], v[76:79], v[56:59], v[136:139]
  v_mfma_f32_16x16x32_bf16 v[140:143], v[76:79], v[60:63], v[140:143]
  s_waitcnt lgkmcnt(0)
  s_barrier
  ds_read_b128 v[48:51], v5 offset:49152
  ds_read_b64_tr_b16 v[64:65], v6 offset:49152
  v_mfma_f32_16x16x32_bf16 v[80:83], v[32:35], v[16:19], v[80:83]
  ds_read_b64_tr_b16 v[66:67], v6 offset:51200
  ds_read_b128 v[52:55], v5 offset:51200
  v_mfma_f32_16x16x32_bf16 v[84:87], v[32:35], v[20:23], v[84:87]
  ds_read_b64_tr_b16 v[68:69], v7 offset:49152
  ds_read_b64_tr_b16 v[70:71], v7 offset:51200
  v_mfma_f32_16x16x32_bf16 v[88:91], v[32:35], v[24:27], v[88:91]
  ds_read_b128 v[56:59], v5 offset:53248
  ds_read_b64_tr_b16 v[72:73], v8 offset:49152
  v_mfma_f32_16x16x32_bf16 v[92:95], v[32:35], v[28:31], v[92:95]
  ds_read_b64_tr_b16 v[74:75], v8 offset:51200
  ds_read_b128 v[60:63], v5 offset:55296
  v_mfma_f32_16x16x32_bf16 v[96:99], v[36:39], v[16:19], v[96:99]
  ds_read_b64_tr_b16 v[76:77], v9 offset:49152
  ds_read_b64_tr_b16 v[78:79], v9 offset:51200
  v_mfma_f32_16x16x32_bf16 v[100:103], v[36:39], v[20:23], v[100:103]
  v_mfma_f32_16x16x32_bf16 v[104:107], v[36:39], v[24:27], v[104:107]
  v_mfma_f32_16x16x32_bf16 v[108:111], v[36:39], v[28:31], v[108:111]
  v_mfma_f32_16x16x32_bf16 v[112:115], v[40:43], v[16:19], v[112:115]
  v_mfma_f32_16x16x32_bf16 v[116:119], v[40:43], v[20:23], v[116:119]
  v_mfma_f32_16x16x32_bf16 v[120:123], v[40:43], v[24:27], v[120:123]
  v_mfma_f32_16x16x32_bf16 v[124:127], v[40:43], v[28:31], v[124:127]
  v_mfma_f32_16x16x32_bf16 v[128:131], v[44:47], v[16:19], v[128:131]
  v_mfma_f32_16x16x32_bf16 v[132:135], v[44:47], v[20:23], v[132:135]
  v_mfma_f32_16x16x32_bf16 v[136:139], v[44:47], v[24:27], v[136:139]
  v_mfma_f32_16x16x32_bf16 v[140:143], v[44:47], v[28:31], v[140:143]
  s_add_u32 s58, s58, 4
  s_cmp_lt_u32 s58, 16
  s_cbranch_scc1 P3_LOOP
  s_waitcnt lgkmcnt(0)

  v_mfma_f32_16x16x32_bf16 v[80:83], v[64:67], v[48:51], v[80:83]
  v_mfma_f32_16x16x32_bf16 v[84:87], v[64:67], v[52:55], v[84:87]
  v_mfma_f32_16x16x32_bf16 v[88:91], v[64:67], v[56:59], v[88:91]
  v_mfma_f32_16x16x32_bf16 v[92:95], v[64:67], v[60:63], v[92:95]
  v_mfma_f32_16x16x32_bf16 v[96:99], v[68:71], v[48:51], v[96:99]
  v_mfma_f32_16x16x32_bf16 v[100:103], v[68:71], v[52:55], v[100:103]
  v_mfma_f32_16x16x32_bf16 v[104:107], v[68:71], v[56:59], v[104:107]
  v_mfma_f32_16x16x32_bf16 v[108:111], v[68:71], v[60:63], v[108:111]
  v_mfma_f32_16x16x32_bf16 v[112:115], v[72:75], v[48:51], v[112:115]
  v_mfma_f32_16x16x32_bf16 v[116:119], v[72:75], v[52:55], v[116:119]
  v_mfma_f32_16x16x32_bf16 v[120:123], v[72:75], v[56:59], v[120:123]
  v_mfma_f32_16x16x32_bf16 v[124:127], v[72:75], v[60:63], v[124:127]
  v_mfma_f32_16x16x32_bf16 v[128:131], v[76:79], v[48:51], v[128:131]
  v_mfma_f32_16x16x32_bf16 v[132:135], v[76:79], v[52:55], v[132:135]
  v_mfma_f32_16x16x32_bf16 v[136:139], v[76:79], v[56:59], v[136:139]
  v_mfma_f32_16x16x32_bf16 v[140:143], v[76:79], v[60:63], v[140:143]
  s_lshl_b32 s60, s24, 13
  v_add_u32 v10, s60, v2
  s_xor_b32 s60, s60, 32768
  v_add_u32 v11, s60, v2
  s_lshl_b32 s60, s49, 7
  s_lshl_b32 s61, s51, 6
  s_add_u32 s60, s60, s61
  s_lshl_b32 s61, s53, 5
  s_add_u32 s60, s60, s61
  s_lshl_b32 s60, s60, 12
  s_lshl_b32 s61, s48, 11
  s_add_u32 s60, s60, s61
  s_lshl_b32 s61, s50, 8
  s_add_u32 s60, s60, s61
  s_lshl_b32 s61, s52, 7
  s_add_u32 s60, s60, s61
  s_add_u32 s61, s60, 65536
  v_and_b32 v12, 15, v1
  v_lshlrev_b32 v12, 12, v12
  v_bfe_u32 v13, v1, 4, 1
  v_lshl_add_u32 v12, v13, 5, v12
  v_lshrrev_b32 v13, 5, v1
  v_lshl_add_u32 v12, v13, 4, v12
  s_barrier
  s_cmp_eq_u32 s53, 0
  s_cbranch_scc1 P3_KS0

  ds_write_b128 v10, v[80:83] offset:0
  ds_write_b128 v10, v[96:99] offset:1024
  ds_write_b128 v10, v[112:115] offset:2048
  ds_write_b128 v10, v[128:131] offset:3072
  ds_write_b128 v10, v[84:87] offset:4096
  ds_write_b128 v10, v[100:103] offset:5120
  ds_write_b128 v10, v[116:119] offset:6144
  ds_write_b128 v10, v[132:135] offset:7168
  s_waitcnt lgkmcnt(0)
  s_barrier
  ds_read_b128 v[16:19], v11 offset:0
  ds_read_b128 v[20:23], v11 offset:1024
  ds_read_b128 v[24:27], v11 offset:2048
  ds_read_b128 v[28:31], v11 offset:3072
  ds_read_b128 v[32:35], v11 offset:4096
  ds_read_b128 v[36:39], v11 offset:5120
  ds_read_b128 v[40:43], v11 offset:6144
  ds_read_b128 v[44:47], v11 offset:7168
  s_waitcnt lgkmcnt(6)
  v_add_f32 v88, v88, v16
  v_add_f32 v89, v89, v17
  v_add_f32 v90, v90, v18
  v_add_f32 v91, v91, v19
  v_add_f32 v104, v104, v20
  v_add_f32 v105, v105, v21
  v_add_f32 v106, v106, v22
  v_add_f32 v107, v107, v23
  v_cvt_pk_bf16_f32 v48, v88, v89
  v_cvt_pk_bf16_f32 v49, v90, v91
  v_cvt_pk_bf16_f32 v50, v104, v105
  v_cvt_pk_bf16_f32 v51, v106, v107
  s_nop 1
  v_permlane16_swap_b32 v48, v50
  v_permlane16_swap_b32 v49, v51
  s_nop 0
  buffer_store_dwordx4 v[48:51], v12, s[44:47], s60 offen offset:0 sc1
  s_waitcnt lgkmcnt(4)
  v_add_f32 v120, v120, v24
  v_add_f32 v121, v121, v25
  v_add_f32 v122, v122, v26
  v_add_f32 v123, v123, v27
  v_add_f32 v136, v136, v28
  v_add_f32 v137, v137, v29
  v_add_f32 v138, v138, v30
  v_add_f32 v139, v139, v31
  v_cvt_pk_bf16_f32 v52, v120, v121
  v_cvt_pk_bf16_f32 v53, v122, v123
  v_cvt_pk_bf16_f32 v54, v136, v137
  v_cvt_pk_bf16_f32 v55, v138, v139
  s_nop 1
  v_permlane16_swap_b32 v52, v54
  v_permlane16_swap_b32 v53, v55
  s_nop 0
  buffer_store_dwordx4 v[52:55], v12, s[44:47], s60 offen offset:64 sc1
  s_waitcnt lgkmcnt(2)
  v_add_f32 v92, v92, v32
  v_add_f32 v93, v93, v33
  v_add_f32 v94, v94, v34
  v_add_f32 v95, v95, v35
  v_add_f32 v108, v108, v36
  v_add_f32 v109, v109, v37
  v_add_f32 v110, v110, v38
  v_add_f32 v111, v111, v39
  v_cvt_pk_bf16_f32 v56, v92, v93
  v_cvt_pk_bf16_f32 v57, v94, v95
  v_cvt_pk_bf16_f32 v58, v108, v109
  v_cvt_pk_bf16_f32 v59, v110, v111
  s_nop 1
  v_permlane16_swap_b32 v56, v58
  v_permlane16_swap_b32 v57, v59
  s_nop 0
  buffer_store_dwordx4 v[56:59], v12, s[44:47], s61 offen offset:0 sc1
  s_waitcnt lgkmcnt(0)
  v_add_f32 v124, v124, v40
  v_add_f32 v125, v125, v41
  v_add_f32 v126, v126, v42
  v_add_f32 v127, v127, v43
  v_add_f32 v140, v140, v44
  v_add_f32 v141, v141, v45
  v_add_f32 v142, v142, v46
  v_add_f32 v143, v143, v47
  v_cvt_pk_bf16_f32 v60, v124, v125
  v_cvt_pk_bf16_f32 v61, v126, v127
  v_cvt_pk_bf16_f32 v62, v140, v141
  v_cvt_pk_bf16_f32 v63, v142, v143
  s_nop 1
  v_permlane16_swap_b32 v60, v62
  v_permlane16_swap_b32 v61, v63
  s_nop 0
  buffer_store_dwordx4 v[60:63], v12, s[44:47], s61 offen offset:64 sc1
  s_branch P3_JOIN
P3_KS0:
  ds_write_b128 v10, v[88:91] offset:0
  ds_write_b128 v10, v[104:107] offset:1024
  ds_write_b128 v10, v[120:123] offset:2048
  ds_write_b128 v10, v[136:139] offset:3072
  ds_write_b128 v10, v[92:95] offset:4096
  ds_write_b128 v10, v[108:111] offset:5120
  ds_write_b128 v10, v[124:127] offset:6144
  ds_write_b128 v10, v[140:143] offset:7168
  s_waitcnt lgkmcnt(0)
  s_barrier
  ds_read_b128 v[16:19], v11 offset:0
  ds_read_b128 v[20:23], v11 offset:1024
  ds_read_b128 v[24:27], v11 offset:2048
  ds_read_b128 v[28:31], v11 offset:3072
  ds_read_b128 v[32:35], v11 offset:4096
  ds_read_b128 v[36:39], v11 offset:5120
  ds_read_b128 v[40:43], v11 offset:6144
  ds_read_b128 v[44:47], v11 offset:7168
  s_waitcnt lgkmcnt(6)
  v_add_f32 v80, v80, v16
  v_add_f32 v81, v81, v17
  v_add_f32 v82, v82, v18
  v_add_f32 v83, v83, v19
  v_add_f32 v96, v96, v20
  v_add_f32 v97, v97, v21
  v_add_f32 v98, v98, v22
  v_add_f32 v99, v99, v23
  v_cvt_pk_bf16_f32 v48, v80, v81
  v_cvt_pk_bf16_f32 v49, v82, v83
  v_cvt_pk_bf16_f32 v50, v96, v97
  v_cvt_pk_bf16_f32 v51, v98, v99
  s_nop 1
  v_permlane16_swap_b32 v48, v50
  v_permlane16_swap_b32 v49, v51
  s_nop 0
  buffer_store_dwordx4 v[48:51], v12, s[44:47], s60 offen offset:0 sc1
  s_waitcnt lgkmcnt(4)
  v_add_f32 v112, v112, v24
  v_add_f32 v113, v113, v25
  v_add_f32 v114, v114, v26
  v_add_f32 v115, v115, v27
  v_add_f32 v128, v128, v28
  v_add_f32 v129, v129, v29
  v_add_f32 v130, v130, v30
  v_add_f32 v131, v131, v31
  v_cvt_pk_bf16_f32 v52, v112, v113
  v_cvt_pk_bf16_f32 v53, v114, v115
  v_cvt_pk_bf16_f32 v54, v128, v129
  v_cvt_pk_bf16_f32 v55, v130, v131
  s_nop 1
  v_permlane16_swap_b32 v52, v54
  v_permlane16_swap_b32 v53, v55
  s_nop 0
  buffer_store_dwordx4 v[52:55], v12, s[44:47], s60 offen offset:64 sc1
  s_waitcnt lgkmcnt(2)
  v_add_f32 v84, v84, v32
  v_add_f32 v85, v85, v33
  v_add_f32 v86, v86, v34
  v_add_f32 v87, v87, v35
  v_add_f32 v100, v100, v36
  v_add_f32 v101, v101, v37
  v_add_f32 v102, v102, v38
  v_add_f32 v103, v103, v39
  v_cvt_pk_bf16_f32 v56, v84, v85
  v_cvt_pk_bf16_f32 v57, v86, v87
  v_cvt_pk_bf16_f32 v58, v100, v101
  v_cvt_pk_bf16_f32 v59, v102, v103
  s_nop 1
  v_permlane16_swap_b32 v56, v58
  v_permlane16_swap_b32 v57, v59
  s_nop 0
  buffer_store_dwordx4 v[56:59], v12, s[44:47], s61 offen offset:0 sc1
  s_waitcnt lgkmcnt(0)
  v_add_f32 v116, v116, v40
  v_add_f32 v117, v117, v41
  v_add_f32 v118, v118, v42
  v_add_f32 v119, v119, v43
  v_add_f32 v132, v132, v44
  v_add_f32 v133, v133, v45
  v_add_f32 v134, v134, v46
  v_add_f32 v135, v135, v47
  v_cvt_pk_bf16_f32 v60, v116, v117
  v_cvt_pk_bf16_f32 v61, v118, v119
  v_cvt_pk_bf16_f32 v62, v132, v133
  v_cvt_pk_bf16_f32 v63, v134, v135
  s_nop 1
  v_permlane16_swap_b32 v60, v62
  v_permlane16_swap_b32 v61, v63
  s_nop 0
  buffer_store_dwordx4 v[60:63], v12, s[44:47], s61 offen offset:64 sc1
P3_JOIN:
END:
  s_endpgm
P2_SPIN:
  s_mov_b32 s57, 0
SP29:
  ds_read_b32 v12, v11 offset:0
  s_add_u32 s57, s57, 1
  s_waitcnt lgkmcnt(0)
  v_readfirstlane_b32 s56, v12
  s_cmp_gt_u32 s57, 2000000
  s_cbranch_scc1 SP29_X
  s_cmp_ge_u32 s56, s62
  s_cbranch_scc1 SP29_X

  s_branch SP29
SP29_X:
  s_mov_b32 s57, 0
SP30:
  ds_read_b32 v12, v11 offset:4
  s_add_u32 s57, s57, 1
  s_waitcnt lgkmcnt(0)
  v_readfirstlane_b32 s56, v12
  s_cmp_gt_u32 s57, 2000000
  s_cbranch_scc1 P2_GO
  s_cmp_ge_u32 s56, s63
  s_cbranch_scc1 P2_GO

  s_sleep 1
  s_branch SP30
P2_SLOW:
  v_mov_b32 v96, 0
  v_mov_b32 v97, 0
  v_mov_b32 v98, 0
  v_mov_b32 v99, 0
  v_mov_b32 v100, 0
  v_mov_b32 v101, 0
  v_mov_b32 v102, 0
  v_mov_b32 v103, 0
  v_mov_b32 v104, 0
  v_mov_b32 v105, 0
  v_mov_b32 v106, 0
  v_mov_b32 v107, 0
  v_mov_b32 v108, 0
  v_mov_b32 v109, 0
  v_mov_b32 v110, 0
  v_mov_b32 v111, 0
  v_mov_b32 v6, 0
  v_mov_b32 v13, 0xff800000
  s_mov_b32 s50, s54
  s_mov_b32 s52, 0
P2_SLOOP:
  buffer_load_dwordx4 v[124:127], v2, s[32:35], s50 offen offset:0 sc1
  buffer_load_dwordx4 v[128:131], v2, s[32:35], s50 offen offset:1024 sc1
  buffer_load_dwordx4 v[140:143], v2, s[32:35], s50 offen offset:2048 sc1
  buffer_load_dwordx4 v[144:147], v2, s[32:35], s50 offen offset:3072 sc1
  s_waitcnt vmcnt(0)
  v_mfma_f32_32x32x16_bf16 v[48:63], v[124:127], v[16:19], 0
  v_mfma_f32_32x32x16_bf16 v[48:63], v[128:131], v[20:23], v[48:63]
  s_nop 15
  v_max3_f32 v12, v48, v49, v50
  v_max3_f32 v12, v12, v51, v52
  v_max3_f32 v12, v12, v53, v54
  v_max3_f32 v12, v12, v55, v56
  v_max3_f32 v12, v12, v57, v58
  v_max3_f32 v12, v12, v59, v60
  v_max3_f32 v12, v12, v61, v62
  v_max3_f32 v12, v12, v63, v13
  v_mov_b32 v7, v12
  v_mov_b32 v8, v12
  s_nop 1
  v_permlane32_swap_b32 v7, v8
  s_nop 1
  v_max_f32 v12, v7, v8
  v_sub_f32 v11, v13, v12
  v_exp_f32 v11, v11
  v_mov_b32 v13, v12
  v_sub_f32 v48, v48, v12
  v_sub_f32 v49, v49, v12
  v_sub_f32 v50, v50, v12
  v_sub_f32 v51, v51, v12
  v_sub_f32 v52, v52, v12
  v_sub_f32 v53, v53, v12
  v_sub_f32 v54, v54, v12
  v_sub_f32 v55, v55, v12
  v_sub_f32 v56, v56, v12
  v_sub_f32 v57, v57, v12
  v_sub_f32 v58, v58, v12
  v_sub_f32 v59, v59, v12
  v_sub_f32 v60, v60, v12
  v_sub_f32 v61, v61, v12
  v_sub_f32 v62, v62, v12
  v_sub_f32 v63, v63, v12
  v_exp_f32 v48, v48
  v_exp_f32 v49, v49
  v_exp_f32 v50, v50
  v_exp_f32 v51, v51
  v_exp_f32 v52, v52
  v_exp_f32 v53, v53
  v_exp_f32 v54, v54
  v_exp_f32 v55, v55
  v_exp_f32 v56, v56
  v_exp_f32 v57, v57
  v_exp_f32 v58, v58
  v_exp_f32 v59, v59
  v_exp_f32 v60, v60
  v_exp_f32 v61, v61
  v_exp_f32 v62, v62
  v_exp_f32 v63, v63
  v_mul_f32 v6, v11, v6
  v_mul_f32 v96, v11, v96
  v_mul_f32 v97, v11, v97
  v_mul_f32 v98, v11, v98
  v_mul_f32 v99, v11, v99
  v_mul_f32 v100, v11, v100
  v_mul_f32 v101, v11, v101
  v_mul_f32 v102, v11, v102
  v_mul_f32 v103, v11, v103
  v_mul_f32 v104, v11, v104
  v_mul_f32 v105, v11, v105
  v_mul_f32 v106, v11, v106
  v_mul_f32 v107, v11, v107
  v_mul_f32 v108, v11, v108
  v_mul_f32 v109, v11, v109
  v_mul_f32 v110, v11, v110
  v_mul_f32 v111, v11, v111
  v_add_f32 v6, v6, v48
  v_add_f32 v6, v6, v49
  v_add_f32 v6, v6, v50
  v_add_f32 v6, v6, v51
  v_add_f32 v6, v6, v52
  v_add_f32 v6, v6, v53
  v_add_f32 v6, v6, v54
  v_add_f32 v6, v6, v55
  v_add_f32 v6, v6, v56
  v_add_f32 v6, v6, v57
  v_add_f32 v6, v6, v58
  v_add_f32 v6, v6, v59
  v_add_f32 v6, v6, v60
  v_add_f32 v6, v6, v61
  v_add_f32 v6, v6, v62
  v_add_f32 v6, v6, v63
  v_cvt_pk_bf16_f32 v80, v48, v49
  v_cvt_pk_bf16_f32 v81, v50, v51
  v_cvt_pk_bf16_f32 v82, v52, v53
  v_cvt_pk_bf16_f32 v83, v54, v55
  v_cvt_pk_bf16_f32 v84, v56, v57
  v_cvt_pk_bf16_f32 v85, v58, v59
  v_cvt_pk_bf16_f32 v86, v60, v61
  v_cvt_pk_bf16_f32 v87, v62, v63
  s_nop 1
  v_mfma_f32_32x32x16_bf16 v[96:111], v[140:143], v[80:83], v[96:111]
  v_mfma_f32_32x32x16_bf16 v[96:111], v[144:147], v[84:87], v[96:111]
  s_add_u32 s50, s50, 4096
  s_add_u32 s52, s52, 1
  s_cmp_lt_u32 s52, 64
  s_cbranch_scc1 P2_SLOOP
  s_nop 15

  v_mov_b32 v7, v6
  v_mov_b32 v8, v6
  s_nop 1
  v_permlane32_swap_b32 v7, v8
  s_nop 1
  v_add_f32 v6, v7, v8
  s_branch P2_FIN
CODE_END:
  s_endpgm
.section .rodata,"a"
.p2align 6
.amdhsa_kernel concat_heads__softmax_full_mha__linear_kernel_hedgehog__prompt_kernel
  .amdhsa_next_free_vgpr 168
  .amdhsa_next_free_sgpr 102
  .amdhsa_accum_offset 168
  .amdhsa_group_segment_fixed_size 0
  .amdhsa_kernarg_size 80
  .amdhsa_user_sgpr_count 2
  .amdhsa_user_sgpr_kernarg_segment_ptr 1
  .amdhsa_system_sgpr_workgroup_id_x 1
  .amdhsa_float_denorm_mode_32 3
.end_amdhsa_kernel
```
